```python
import torch

def _softmax(x, axis=-1):
    return torch.softmax(x, dim=axis)

def _gelu(x):
    return torch.nn.functional.gelu(x, approximate='tanh')

def _silu(x):
    return torch.nn.functional.silu(x)

def _sigmoid(x):
    return torch.sigmoid(x)

def _layernorm(x, axis=-1, eps=1e-05):
    m = x.mean(dim=axis, keepdim=True)
    v = x.var(dim=axis, keepdim=True, unbiased=False)
    return (x - m) / torch.sqrt(v + eps)

def _scatter_add(tgt, idx, src, axis=0):
    return tgt.clone().index_add_(axis, idx, src)

def _segment_sum(src, seg, n):
    out = torch.zeros((n,) + src.shape[1:], dtype=src.dtype)
    return out.index_add_(0, seg, src)

def _pad(x, pw):
    flat = tuple((v for pair in reversed(pw) for v in pair))
    return torch.nn.functional.pad(x, flat)
kernel_name = 'adaLN_cond__ssm_conv_s4__mixer_s_mlp__prompt'

def setup_inputs():

    _w = lambda a: (lambda t: t.to(torch.bfloat16) if t.is_floating_point() else t)(torch.as_tensor(a))

    def _A_setup():
        B, L, D, N = (1, 2048, 448, 256)
        A_re = -(lambda _x: torch.exp(torch.as_tensor(_x)))((lambda *s: torch.randn(*s, dtype=torch.bfloat16) * 3.2)(D, N))
        A_im = torch.pi * (lambda *s: torch.randn(*s, dtype=torch.bfloat16) * 0.1)(D, N)
        B_re = (lambda *s: torch.randn(*s, dtype=torch.bfloat16) * 0.2)(D, N)
        B_im = (lambda *s: torch.randn(*s, dtype=torch.bfloat16) * 0.2)(D, N)
        C_re = (lambda *s: torch.randn(*s, dtype=torch.bfloat16) * 0.2)(D, N)
        C_im = (lambda *s: torch.randn(*s, dtype=torch.bfloat16) * 0.2)(D, N)
        log_dt = (lambda *s: torch.randn(*s, dtype=torch.bfloat16) * 0.1)(D) * 0.5 - 4.0
        Dskip = (lambda *s: torch.randn(*s, dtype=torch.bfloat16) * 0.1)(D)
        return {'u': _w((lambda *s: torch.randn(*s, dtype=torch.bfloat16) * 0.05)(B, L, D)), 'A_re': _w(A_re), 'A_im': _w(A_im), 'B_re': _w(B_re), 'B_im': _w(B_im), 'C_re': _w(C_re), 'C_im': _w(C_im), 'log_dt': _w(log_dt), 'Dskip': _w(Dskip)}
    _A_in = _A_setup()

    def _B_setup():
        B, S, D, F = (1, 2048, 448, 1792)
        return {'x': _w((lambda *s: torch.randn(*s, dtype=torch.bfloat16) * 0.05)(B, S, D)), 'w1': _w((lambda *s: torch.randn(*s, dtype=torch.bfloat16) * 3.2)(D, D) * D ** (-0.5)), 'w2': _w((lambda *s: torch.randn(*s, dtype=torch.bfloat16) * 3.2)(D, D) * D ** (-0.5)), 'w3': _w((lambda *s: torch.randn(*s, dtype=torch.bfloat16) * 3.2)(D, F) * D ** (-0.5)), 'w4': _w((lambda *s: torch.randn(*s, dtype=torch.bfloat16) * 3.2)(F, D) * F ** (-0.5))}
    _B_in = _B_setup()
    return {'A_u': _A_in['u'], 'A_A_re': _A_in['A_re'], 'A_A_im': _A_in['A_im'], 'A_B_re': _A_in['B_re'], 'A_B_im': _A_in['B_im'], 'A_C_re': _A_in['C_re'], 'A_C_im': _A_in['C_im'], 'A_log_dt': _A_in['log_dt'], 'A_Dskip': _A_in['Dskip'], 'B_x': _B_in['x'], 'B_w1': _B_in['w1'], 'B_w2': _B_in['w2'], 'B_w3': _B_in['w3'], 'B_w4': _B_in['w4'], 'c': _w((lambda *s: torch.randn(*s, dtype=torch.bfloat16) * 0.1)(1, 448) * 8.0), 'w_mod': _w((lambda *s: torch.randn(*s, dtype=torch.bfloat16) * 0.1)(448, 6 * 448) * 448 ** (-0.5) * 8.0)}

def reference(A_u, A_A_re, A_A_im, A_B_re, A_B_im, A_C_re, A_C_im, A_log_dt, A_Dskip, B_x, B_w1, B_w2, B_w3, B_w4, c, w_mod):

    def _A_ref(u, A_re, A_im, B_re, B_im, C_re, C_im, log_dt, Dskip):
        Bsz, L, D = u.shape
        dt = torch.exp(log_dt)[:, None]
        A = A_re + 1j * A_im
        Bc = B_re + 1j * B_im
        Cc = C_re + 1j * C_im
        logdA = dt * A
        dB = dt * Bc
        l = (lambda x, dt: x.to(dt))(torch.arange(L), A_re.dtype)
        P = torch.exp(logdA[:, :, None] * l[None, None, :])
        K = torch.einsum('dn,dnl,dn->dl', Cc, P, dB).real
        L2 = 2 * L
        Kp = _pad(K, ((0, 0), (0, L)))
        up = (lambda x, *d: x.permute(*d))(u, 0, 2, 1)
        up = _pad(up, ((0, 0), (0, 0), (0, L)))
        Kf = (lambda x, axes=(-2, -1): torch.fft.rfft2(x.float(), dim=axes))(Kp[:, None, :], axes=(-2, -1))
        Uf = (lambda x, axes=(-2, -1): torch.fft.rfft2(x.float(), dim=axes))(up[:, :, None, :], axes=(-2, -1))
        Yf = Uf * Kf[None, :, :, :]
        y = (lambda x, s, axes=(-2, -1): torch.fft.irfft2(x, s=s, dim=axes).to(torch.bfloat16))(Yf, (1, L2), axes=(-2, -1))[:, :, 0, :L]
        y = (lambda x, *d: x.permute(*d))(y, 0, 2, 1) + u * Dskip[None, None, :]
        return y

    def _B_ref(x, w1, w2, w3, w4):
        B, S, D = x.shape
        h = _gelu(_layernorm(x, axis=-1) @ w1)
        c = D // 4
        g0 = _pad(h[:, :, 0 * c:1 * c], ((0, 0), (1, 0), (0, 0)))[:, :S, :]
        g1 = _pad(h[:, :, 1 * c:2 * c], ((0, 0), (0, 1), (0, 0)))[:, 1:, :]
        g2 = _pad(h[:, :, 2 * c:3 * c], ((0, 0), (2, 0), (0, 0)))[:, :S, :]
        g3 = _pad(h[:, :, 3 * c:], ((0, 0), (0, 2), (0, 0)))[:, 2:, :]
        hs = torch.concatenate([g0, g1, g2, g3], axis=-1) @ w2
        x1 = x + hs
        h2 = _gelu(_layernorm(x1, axis=-1) @ w3) @ w4
        return x1 + h2
    x = A_u
    mod = (_silu(c) @ w_mod).reshape(c.shape[0], 6, 1, -1)
    sa, ca, ga, sb, cb, gb = (mod[:, 0].clone(), mod[:, 1].clone(), mod[:, 2].clone(), mod[:, 3].clone(), mod[:, 4].clone(), mod[:, 5].clone())
    h = _layernorm(x, axis=-1) * (1 + ca) + sa
    x = x + ga * _A_ref(h, A_A_re, A_A_im, A_B_re, A_B_im, A_C_re, A_C_im, A_log_dt, A_Dskip)
    h = _layernorm(x, axis=-1) * (1 + cb) + sb
    x = x + gb * _B_ref(h, B_w1, B_w2, B_w3, B_w4)
    return x
```

```asm
; @launch kernel=ka_kernel grid=(722,1,1) block=(256,1,1) lds=46288
; @launch kernel=kb_kernel grid=(256,1,1) block=(512,1,1) lds=115776
.amdgcn_target "amdgcn-amd-amdhsa--gfx950"
.text
.globl ka_kernel
.p2align 8
.type ka_kernel,@function
ka_kernel:
    s_cmp_ge_u32 s2, 722
    s_cbranch_scc1 ka_end
    s_load_dwordx16 s[16:31], s[0:1], 0
    s_load_dwordx16 s[32:47], s[0:1], 64
    s_load_dwordx4 s[48:51], s[0:1], 128
    s_load_dwordx2 s[52:53], s[0:1], 144
    v_and_b32 v1, 63, v0
    v_lshrrev_b32 v2, 6, v0
    v_and_b32 v3, 15, v0
    v_bfe_u32 v4, v0, 4, 2
    v_readfirstlane_b32 s7, v2
    s_getpc_b64 s[8:9]
k1_pc:
    s_lshr_b32 s10, s2, 6
    s_lshl_b32 s10, s10, 12
    s_sub_u32 s8, s8, k1_pc-ka_kernel
    s_subb_u32 s9, s9, 0
    v_lshl_add_u32 v5, v0, 4, s10
    v_min_u32 v5, 37312, v5
    global_load_dwordx4 v[156:159], v5, s[8:9]
    s_sub_u32 s4, s2, 274
    s_cmp_ge_u32 s2, 274
    s_cbranch_scc1 ka_ssm
    s_waitcnt lgkmcnt(0)
    s_sub_u32 s4, s2, 134
    s_cmp_ge_u32 s2, 134
    s_cbranch_scc1 ka_rp
    s_sub_u32 s4, s2, 106
    s_cmp_ge_u32 s2, 106
    s_cbranch_scc1 ka_cs
    s_sub_u32 s4, s2, 64
    s_cmp_ge_u32 s2, 64
    s_cbranch_scc1 ka_mod
    s_mov_b32 s4, s2
    s_setprio 3
    s_mov_b32 s56, s16
    s_mov_b32 s57, s17
    s_mov_b32 s58, 1835008
    s_mov_b32 s59, 0x00020000
    s_add_u32 s60, s52, 1048576
    s_addc_u32 s61, s53, 0
    s_mov_b32 s62, 1835008
    s_mov_b32 s63, 0x00020000
    s_mul_i32 s5, s4, 28672
    v_lshl_add_u32 v5, v2, 3, v4
    v_mul_u32_u24 v6, 896, v5
    v_lshl_add_u32 v6, v3, 3, v6
    v_add_u32 v7, 3584, v6
    buffer_load_dwordx2 v[10:11], v6, s[56:59], s5 offen offset:0
    buffer_load_dwordx2 v[12:13], v6, s[56:59], s5 offen offset:128
    buffer_load_dwordx2 v[14:15], v6, s[56:59], s5 offen offset:256
    buffer_load_dwordx2 v[16:17], v6, s[56:59], s5 offen offset:384
    buffer_load_dwordx2 v[18:19], v6, s[56:59], s5 offen offset:512
    buffer_load_dwordx2 v[20:21], v6, s[56:59], s5 offen offset:640
    buffer_load_dwordx2 v[22:23], v6, s[56:59], s5 offen offset:768
    buffer_load_dwordx2 v[24:25], v7, s[56:59], s5 offen offset:0
    buffer_load_dwordx2 v[26:27], v7, s[56:59], s5 offen offset:128
    buffer_load_dwordx2 v[28:29], v7, s[56:59], s5 offen offset:256
    buffer_load_dwordx2 v[30:31], v7, s[56:59], s5 offen offset:384
    buffer_load_dwordx2 v[32:33], v7, s[56:59], s5 offen offset:512
    buffer_load_dwordx2 v[34:35], v7, s[56:59], s5 offen offset:640
    buffer_load_dwordx2 v[36:37], v7, s[56:59], s5 offen offset:768
    v_mul_u32_u24 v8, 904, v5
    v_lshl_add_u32 v8, v3, 3, v8
    s_waitcnt vmcnt(7)
    v_lshlrev_b32 v40, 16, v10
    v_and_b32 v41, 0xffff0000, v10
    v_lshlrev_b32 v42, 16, v11
    v_and_b32 v43, 0xffff0000, v11
    v_lshlrev_b32 v44, 16, v12
    v_and_b32 v45, 0xffff0000, v12
    v_lshlrev_b32 v46, 16, v13
    v_and_b32 v47, 0xffff0000, v13
    v_lshlrev_b32 v48, 16, v14
    v_and_b32 v49, 0xffff0000, v14
    v_lshlrev_b32 v50, 16, v15
    v_and_b32 v51, 0xffff0000, v15
    v_lshlrev_b32 v52, 16, v16
    v_and_b32 v53, 0xffff0000, v16
    v_lshlrev_b32 v54, 16, v17
    v_and_b32 v55, 0xffff0000, v17
    v_lshlrev_b32 v56, 16, v18
    v_and_b32 v57, 0xffff0000, v18
    v_lshlrev_b32 v58, 16, v19
    v_and_b32 v59, 0xffff0000, v19
    v_lshlrev_b32 v60, 16, v20
    v_and_b32 v61, 0xffff0000, v20
    v_lshlrev_b32 v62, 16, v21
    v_and_b32 v63, 0xffff0000, v21
    v_lshlrev_b32 v64, 16, v22
    v_and_b32 v65, 0xffff0000, v22
    v_lshlrev_b32 v66, 16, v23
    v_and_b32 v67, 0xffff0000, v23
    v_add_f32 v68, v40, v44
    v_add_f32 v69, v41, v45
    v_add_f32 v70, v42, v46
    v_add_f32 v71, v43, v47
    v_add_f32 v68, v68, v48
    v_add_f32 v69, v69, v49
    v_add_f32 v70, v70, v50
    v_add_f32 v71, v71, v51
    v_add_f32 v68, v68, v52
    v_add_f32 v69, v69, v53
    v_add_f32 v70, v70, v54
    v_add_f32 v71, v71, v55
    v_add_f32 v68, v68, v56
    v_add_f32 v69, v69, v57
    v_add_f32 v70, v70, v58
    v_add_f32 v71, v71, v59
    v_add_f32 v68, v68, v60
    v_add_f32 v69, v69, v61
    v_add_f32 v70, v70, v62
    v_add_f32 v71, v71, v63
    v_add_f32 v68, v68, v64
    v_add_f32 v69, v69, v65
    v_add_f32 v70, v70, v66
    v_add_f32 v71, v71, v67
    v_add_f32 v68, v68, v69
    v_add_f32 v70, v70, v71
    v_add_f32 v73, v68, v70
    s_nop 1
    v_add_f32_dpp v72, v73, v73 row_ror:8 row_mask:0xf bank_mask:0xf
    s_nop 1
    v_add_f32_dpp v73, v72, v72 row_ror:4 row_mask:0xf bank_mask:0xf
    s_nop 1
    v_add_f32_dpp v72, v73, v73 row_ror:2 row_mask:0xf bank_mask:0xf
    s_nop 1
    v_add_f32_dpp v73, v72, v72 row_ror:1 row_mask:0xf bank_mask:0xf
    v_mul_f32 v73, 0x3b124925, v73
    v_sub_f32 v72, v40, v73
    v_mul_f32 v68, v72, v72
    v_sub_f32 v74, v41, v73
    v_mul_f32 v69, v74, v74
    v_sub_f32 v72, v42, v73
    v_mul_f32 v70, v72, v72
    v_sub_f32 v74, v43, v73
    v_mul_f32 v71, v74, v74
    v_sub_f32 v72, v44, v73
    v_fmac_f32 v68, v72, v72
    v_sub_f32 v74, v45, v73
    v_fmac_f32 v69, v74, v74
    v_sub_f32 v72, v46, v73
    v_fmac_f32 v70, v72, v72
    v_sub_f32 v74, v47, v73
    v_fmac_f32 v71, v74, v74
    v_sub_f32 v72, v48, v73
    v_fmac_f32 v68, v72, v72
    v_sub_f32 v74, v49, v73
    v_fmac_f32 v69, v74, v74
    v_sub_f32 v72, v50, v73
    v_fmac_f32 v70, v72, v72
    v_sub_f32 v74, v51, v73
    v_fmac_f32 v71, v74, v74
    v_sub_f32 v72, v52, v73
    v_fmac_f32 v68, v72, v72
    v_sub_f32 v74, v53, v73
    v_fmac_f32 v69, v74, v74
    v_sub_f32 v72, v54, v73
    v_fmac_f32 v70, v72, v72
    v_sub_f32 v74, v55, v73
    v_fmac_f32 v71, v74, v74
    v_sub_f32 v72, v56, v73
    v_fmac_f32 v68, v72, v72
    v_sub_f32 v74, v57, v73
    v_fmac_f32 v69, v74, v74
    v_sub_f32 v72, v58, v73
    v_fmac_f32 v70, v72, v72
    v_sub_f32 v74, v59, v73
    v_fmac_f32 v71, v74, v74
    v_sub_f32 v72, v60, v73
    v_fmac_f32 v68, v72, v72
    v_sub_f32 v74, v61, v73
    v_fmac_f32 v69, v74, v74
    v_sub_f32 v72, v62, v73
    v_fmac_f32 v70, v72, v72
    v_sub_f32 v74, v63, v73
    v_fmac_f32 v71, v74, v74
    v_sub_f32 v72, v64, v73
    v_fmac_f32 v68, v72, v72
    v_sub_f32 v74, v65, v73
    v_fmac_f32 v69, v74, v74
    v_sub_f32 v72, v66, v73
    v_fmac_f32 v70, v72, v72
    v_sub_f32 v74, v67, v73
    v_fmac_f32 v71, v74, v74
    v_add_f32 v68, v68, v69
    v_add_f32 v70, v70, v71
    v_add_f32 v75, v68, v70
    s_nop 1
    v_add_f32_dpp v72, v75, v75 row_ror:8 row_mask:0xf bank_mask:0xf
    s_nop 1
    v_add_f32_dpp v75, v72, v72 row_ror:4 row_mask:0xf bank_mask:0xf
    s_nop 1
    v_add_f32_dpp v72, v75, v75 row_ror:2 row_mask:0xf bank_mask:0xf
    s_nop 1
    v_add_f32_dpp v75, v72, v72 row_ror:1 row_mask:0xf bank_mask:0xf
    v_mul_f32 v75, 0x3b124925, v75
    v_cvt_pk_bf16_f32 v75, 0, v75
    v_add_f32 v75, 0x3727c5ac, v75
    v_cvt_pk_bf16_f32 v75, 0, v75
    v_sqrt_f32 v75, v75
    s_nop 0
    v_cvt_pk_bf16_f32 v75, 0, v75
    v_rcp_f32 v75, v75
    v_cvt_pk_bf16_f32 v74, 0, v73
    v_sub_f32 v40, v40, v74
    v_sub_f32 v41, v41, v74
    v_sub_f32 v42, v42, v74
    v_sub_f32 v43, v43, v74
    v_sub_f32 v44, v44, v74
    v_sub_f32 v45, v45, v74
    v_sub_f32 v46, v46, v74
    v_sub_f32 v47, v47, v74
    v_sub_f32 v48, v48, v74
    v_sub_f32 v49, v49, v74
    v_sub_f32 v50, v50, v74
    v_sub_f32 v51, v51, v74
    v_sub_f32 v52, v52, v74
    v_sub_f32 v53, v53, v74
    v_sub_f32 v54, v54, v74
    v_sub_f32 v55, v55, v74
    v_sub_f32 v56, v56, v74
    v_sub_f32 v57, v57, v74
    v_sub_f32 v58, v58, v74
    v_sub_f32 v59, v59, v74
    v_sub_f32 v60, v60, v74
    v_sub_f32 v61, v61, v74
    v_sub_f32 v62, v62, v74
    v_sub_f32 v63, v63, v74
    v_sub_f32 v64, v64, v74
    v_sub_f32 v65, v65, v74
    v_sub_f32 v66, v66, v74
    v_sub_f32 v67, v67, v74
    v_cvt_pk_bf16_f32 v40, 0, v40
    v_cvt_pk_bf16_f32 v41, 0, v41
    v_cvt_pk_bf16_f32 v42, 0, v42
    v_cvt_pk_bf16_f32 v43, 0, v43
    v_cvt_pk_bf16_f32 v44, 0, v44
    v_cvt_pk_bf16_f32 v45, 0, v45
    v_cvt_pk_bf16_f32 v46, 0, v46
    v_cvt_pk_bf16_f32 v47, 0, v47
    v_cvt_pk_bf16_f32 v48, 0, v48
    v_cvt_pk_bf16_f32 v49, 0, v49
    v_cvt_pk_bf16_f32 v50, 0, v50
    v_cvt_pk_bf16_f32 v51, 0, v51
    v_cvt_pk_bf16_f32 v52, 0, v52
    v_cvt_pk_bf16_f32 v53, 0, v53
    v_cvt_pk_bf16_f32 v54, 0, v54
    v_cvt_pk_bf16_f32 v55, 0, v55
    v_cvt_pk_bf16_f32 v56, 0, v56
    v_cvt_pk_bf16_f32 v57, 0, v57
    v_cvt_pk_bf16_f32 v58, 0, v58
    v_cvt_pk_bf16_f32 v59, 0, v59
    v_cvt_pk_bf16_f32 v60, 0, v60
    v_cvt_pk_bf16_f32 v61, 0, v61
    v_cvt_pk_bf16_f32 v62, 0, v62
    v_cvt_pk_bf16_f32 v63, 0, v63
    v_cvt_pk_bf16_f32 v64, 0, v64
    v_cvt_pk_bf16_f32 v65, 0, v65
    v_cvt_pk_bf16_f32 v66, 0, v66
    v_cvt_pk_bf16_f32 v67, 0, v67
    v_mul_f32 v40, v40, v75
    v_mul_f32 v41, v41, v75
    v_mul_f32 v42, v42, v75
    v_mul_f32 v43, v43, v75
    v_mul_f32 v44, v44, v75
    v_mul_f32 v45, v45, v75
    v_mul_f32 v46, v46, v75
    v_mul_f32 v47, v47, v75
    v_mul_f32 v48, v48, v75
    v_mul_f32 v49, v49, v75
    v_mul_f32 v50, v50, v75
    v_mul_f32 v51, v51, v75
    v_mul_f32 v52, v52, v75
    v_mul_f32 v53, v53, v75
    v_mul_f32 v54, v54, v75
    v_mul_f32 v55, v55, v75
    v_mul_f32 v56, v56, v75
    v_mul_f32 v57, v57, v75
    v_mul_f32 v58, v58, v75
    v_mul_f32 v59, v59, v75
    v_mul_f32 v60, v60, v75
    v_mul_f32 v61, v61, v75
    v_mul_f32 v62, v62, v75
    v_mul_f32 v63, v63, v75
    v_mul_f32 v64, v64, v75
    v_mul_f32 v65, v65, v75
    v_mul_f32 v66, v66, v75
    v_mul_f32 v67, v67, v75
    v_cvt_pk_bf16_f32 v10, v40, v41
    v_cvt_pk_bf16_f32 v11, v42, v43
    v_cvt_pk_bf16_f32 v12, v44, v45
    v_cvt_pk_bf16_f32 v13, v46, v47
    v_cvt_pk_bf16_f32 v14, v48, v49
    v_cvt_pk_bf16_f32 v15, v50, v51
    v_cvt_pk_bf16_f32 v16, v52, v53
    v_cvt_pk_bf16_f32 v17, v54, v55
    v_cvt_pk_bf16_f32 v18, v56, v57
    v_cvt_pk_bf16_f32 v19, v58, v59
    v_cvt_pk_bf16_f32 v20, v60, v61
    v_cvt_pk_bf16_f32 v21, v62, v63
    v_cvt_pk_bf16_f32 v22, v64, v65
    v_cvt_pk_bf16_f32 v23, v66, v67
    ds_write_b64 v8, v[10:11] offset:0
    ds_write_b64 v8, v[12:13] offset:128
    ds_write_b64 v8, v[14:15] offset:256
    ds_write_b64 v8, v[16:17] offset:384
    ds_write_b64 v8, v[18:19] offset:512
    ds_write_b64 v8, v[20:21] offset:640
    ds_write_b64 v8, v[22:23] offset:768
    s_waitcnt vmcnt(0)
    v_lshlrev_b32 v40, 16, v24
    v_and_b32 v41, 0xffff0000, v24
    v_lshlrev_b32 v42, 16, v25
    v_and_b32 v43, 0xffff0000, v25
    v_lshlrev_b32 v44, 16, v26
    v_and_b32 v45, 0xffff0000, v26
    v_lshlrev_b32 v46, 16, v27
    v_and_b32 v47, 0xffff0000, v27
    v_lshlrev_b32 v48, 16, v28
    v_and_b32 v49, 0xffff0000, v28
    v_lshlrev_b32 v50, 16, v29
    v_and_b32 v51, 0xffff0000, v29
    v_lshlrev_b32 v52, 16, v30
    v_and_b32 v53, 0xffff0000, v30
    v_lshlrev_b32 v54, 16, v31
    v_and_b32 v55, 0xffff0000, v31
    v_lshlrev_b32 v56, 16, v32
    v_and_b32 v57, 0xffff0000, v32
    v_lshlrev_b32 v58, 16, v33
    v_and_b32 v59, 0xffff0000, v33
    v_lshlrev_b32 v60, 16, v34
    v_and_b32 v61, 0xffff0000, v34
    v_lshlrev_b32 v62, 16, v35
    v_and_b32 v63, 0xffff0000, v35
    v_lshlrev_b32 v64, 16, v36
    v_and_b32 v65, 0xffff0000, v36
    v_lshlrev_b32 v66, 16, v37
    v_and_b32 v67, 0xffff0000, v37
    v_add_f32 v68, v40, v44
    v_add_f32 v69, v41, v45
    v_add_f32 v70, v42, v46
    v_add_f32 v71, v43, v47
    v_add_f32 v68, v68, v48
    v_add_f32 v69, v69, v49
    v_add_f32 v70, v70, v50
    v_add_f32 v71, v71, v51
    v_add_f32 v68, v68, v52
    v_add_f32 v69, v69, v53
    v_add_f32 v70, v70, v54
    v_add_f32 v71, v71, v55
    v_add_f32 v68, v68, v56
    v_add_f32 v69, v69, v57
    v_add_f32 v70, v70, v58
    v_add_f32 v71, v71, v59
    v_add_f32 v68, v68, v60
    v_add_f32 v69, v69, v61
    v_add_f32 v70, v70, v62
    v_add_f32 v71, v71, v63
    v_add_f32 v68, v68, v64
    v_add_f32 v69, v69, v65
    v_add_f32 v70, v70, v66
    v_add_f32 v71, v71, v67
    v_add_f32 v68, v68, v69
    v_add_f32 v70, v70, v71
    v_add_f32 v73, v68, v70
    s_nop 1
    v_add_f32_dpp v72, v73, v73 row_ror:8 row_mask:0xf bank_mask:0xf
    s_nop 1
    v_add_f32_dpp v73, v72, v72 row_ror:4 row_mask:0xf bank_mask:0xf
    s_nop 1
    v_add_f32_dpp v72, v73, v73 row_ror:2 row_mask:0xf bank_mask:0xf
    s_nop 1
    v_add_f32_dpp v73, v72, v72 row_ror:1 row_mask:0xf bank_mask:0xf
    v_mul_f32 v73, 0x3b124925, v73
    v_sub_f32 v72, v40, v73
    v_mul_f32 v68, v72, v72
    v_sub_f32 v74, v41, v73
    v_mul_f32 v69, v74, v74
    v_sub_f32 v72, v42, v73
    v_mul_f32 v70, v72, v72
    v_sub_f32 v74, v43, v73
    v_mul_f32 v71, v74, v74
    v_sub_f32 v72, v44, v73
    v_fmac_f32 v68, v72, v72
    v_sub_f32 v74, v45, v73
    v_fmac_f32 v69, v74, v74
    v_sub_f32 v72, v46, v73
    v_fmac_f32 v70, v72, v72
    v_sub_f32 v74, v47, v73
    v_fmac_f32 v71, v74, v74
    v_sub_f32 v72, v48, v73
    v_fmac_f32 v68, v72, v72
    v_sub_f32 v74, v49, v73
    v_fmac_f32 v69, v74, v74
    v_sub_f32 v72, v50, v73
    v_fmac_f32 v70, v72, v72
    v_sub_f32 v74, v51, v73
    v_fmac_f32 v71, v74, v74
    v_sub_f32 v72, v52, v73
    v_fmac_f32 v68, v72, v72
    v_sub_f32 v74, v53, v73
    v_fmac_f32 v69, v74, v74
    v_sub_f32 v72, v54, v73
    v_fmac_f32 v70, v72, v72
    v_sub_f32 v74, v55, v73
    v_fmac_f32 v71, v74, v74
    v_sub_f32 v72, v56, v73
    v_fmac_f32 v68, v72, v72
    v_sub_f32 v74, v57, v73
    v_fmac_f32 v69, v74, v74
    v_sub_f32 v72, v58, v73
    v_fmac_f32 v70, v72, v72
    v_sub_f32 v74, v59, v73
    v_fmac_f32 v71, v74, v74
    v_sub_f32 v72, v60, v73
    v_fmac_f32 v68, v72, v72
    v_sub_f32 v74, v61, v73
    v_fmac_f32 v69, v74, v74
    v_sub_f32 v72, v62, v73
    v_fmac_f32 v70, v72, v72
    v_sub_f32 v74, v63, v73
    v_fmac_f32 v71, v74, v74
    v_sub_f32 v72, v64, v73
    v_fmac_f32 v68, v72, v72
    v_sub_f32 v74, v65, v73
    v_fmac_f32 v69, v74, v74
    v_sub_f32 v72, v66, v73
    v_fmac_f32 v70, v72, v72
    v_sub_f32 v74, v67, v73
    v_fmac_f32 v71, v74, v74
    v_add_f32 v68, v68, v69
    v_add_f32 v70, v70, v71
    v_add_f32 v75, v68, v70
    s_nop 1
    v_add_f32_dpp v72, v75, v75 row_ror:8 row_mask:0xf bank_mask:0xf
    s_nop 1
    v_add_f32_dpp v75, v72, v72 row_ror:4 row_mask:0xf bank_mask:0xf
    s_nop 1
    v_add_f32_dpp v72, v75, v75 row_ror:2 row_mask:0xf bank_mask:0xf
    s_nop 1
    v_add_f32_dpp v75, v72, v72 row_ror:1 row_mask:0xf bank_mask:0xf
    v_mul_f32 v75, 0x3b124925, v75
    v_cvt_pk_bf16_f32 v75, 0, v75
    v_add_f32 v75, 0x3727c5ac, v75
    v_cvt_pk_bf16_f32 v75, 0, v75
    v_sqrt_f32 v75, v75
    s_nop 0
    v_cvt_pk_bf16_f32 v75, 0, v75
    v_rcp_f32 v75, v75
    v_cvt_pk_bf16_f32 v74, 0, v73
    v_sub_f32 v40, v40, v74
    v_sub_f32 v41, v41, v74
    v_sub_f32 v42, v42, v74
    v_sub_f32 v43, v43, v74
    v_sub_f32 v44, v44, v74
    v_sub_f32 v45, v45, v74
    v_sub_f32 v46, v46, v74
    v_sub_f32 v47, v47, v74
    v_sub_f32 v48, v48, v74
    v_sub_f32 v49, v49, v74
    v_sub_f32 v50, v50, v74
    v_sub_f32 v51, v51, v74
    v_sub_f32 v52, v52, v74
    v_sub_f32 v53, v53, v74
    v_sub_f32 v54, v54, v74
    v_sub_f32 v55, v55, v74
    v_sub_f32 v56, v56, v74
    v_sub_f32 v57, v57, v74
    v_sub_f32 v58, v58, v74
    v_sub_f32 v59, v59, v74
    v_sub_f32 v60, v60, v74
    v_sub_f32 v61, v61, v74
    v_sub_f32 v62, v62, v74
    v_sub_f32 v63, v63, v74
    v_sub_f32 v64, v64, v74
    v_sub_f32 v65, v65, v74
    v_sub_f32 v66, v66, v74
    v_sub_f32 v67, v67, v74
    v_cvt_pk_bf16_f32 v40, 0, v40
    v_cvt_pk_bf16_f32 v41, 0, v41
    v_cvt_pk_bf16_f32 v42, 0, v42
    v_cvt_pk_bf16_f32 v43, 0, v43
    v_cvt_pk_bf16_f32 v44, 0, v44
    v_cvt_pk_bf16_f32 v45, 0, v45
    v_cvt_pk_bf16_f32 v46, 0, v46
    v_cvt_pk_bf16_f32 v47, 0, v47
    v_cvt_pk_bf16_f32 v48, 0, v48
    v_cvt_pk_bf16_f32 v49, 0, v49
    v_cvt_pk_bf16_f32 v50, 0, v50
    v_cvt_pk_bf16_f32 v51, 0, v51
    v_cvt_pk_bf16_f32 v52, 0, v52
    v_cvt_pk_bf16_f32 v53, 0, v53
    v_cvt_pk_bf16_f32 v54, 0, v54
    v_cvt_pk_bf16_f32 v55, 0, v55
    v_cvt_pk_bf16_f32 v56, 0, v56
    v_cvt_pk_bf16_f32 v57, 0, v57
    v_cvt_pk_bf16_f32 v58, 0, v58
    v_cvt_pk_bf16_f32 v59, 0, v59
    v_cvt_pk_bf16_f32 v60, 0, v60
    v_cvt_pk_bf16_f32 v61, 0, v61
    v_cvt_pk_bf16_f32 v62, 0, v62
    v_cvt_pk_bf16_f32 v63, 0, v63
    v_cvt_pk_bf16_f32 v64, 0, v64
    v_cvt_pk_bf16_f32 v65, 0, v65
    v_cvt_pk_bf16_f32 v66, 0, v66
    v_cvt_pk_bf16_f32 v67, 0, v67
    v_mul_f32 v40, v40, v75
    v_mul_f32 v41, v41, v75
    v_mul_f32 v42, v42, v75
    v_mul_f32 v43, v43, v75
    v_mul_f32 v44, v44, v75
    v_mul_f32 v45, v45, v75
    v_mul_f32 v46, v46, v75
    v_mul_f32 v47, v47, v75
    v_mul_f32 v48, v48, v75
    v_mul_f32 v49, v49, v75
    v_mul_f32 v50, v50, v75
    v_mul_f32 v51, v51, v75
    v_mul_f32 v52, v52, v75
    v_mul_f32 v53, v53, v75
    v_mul_f32 v54, v54, v75
    v_mul_f32 v55, v55, v75
    v_mul_f32 v56, v56, v75
    v_mul_f32 v57, v57, v75
    v_mul_f32 v58, v58, v75
    v_mul_f32 v59, v59, v75
    v_mul_f32 v60, v60, v75
    v_mul_f32 v61, v61, v75
    v_mul_f32 v62, v62, v75
    v_mul_f32 v63, v63, v75
    v_mul_f32 v64, v64, v75
    v_mul_f32 v65, v65, v75
    v_mul_f32 v66, v66, v75
    v_mul_f32 v67, v67, v75
    v_cvt_pk_bf16_f32 v24, v40, v41
    v_cvt_pk_bf16_f32 v25, v42, v43
    v_cvt_pk_bf16_f32 v26, v44, v45
    v_cvt_pk_bf16_f32 v27, v46, v47
    v_cvt_pk_bf16_f32 v28, v48, v49
    v_cvt_pk_bf16_f32 v29, v50, v51
    v_cvt_pk_bf16_f32 v30, v52, v53
    v_cvt_pk_bf16_f32 v31, v54, v55
    v_cvt_pk_bf16_f32 v32, v56, v57
    v_cvt_pk_bf16_f32 v33, v58, v59
    v_cvt_pk_bf16_f32 v34, v60, v61
    v_cvt_pk_bf16_f32 v35, v62, v63
    v_cvt_pk_bf16_f32 v36, v64, v65
    v_cvt_pk_bf16_f32 v37, v66, v67
    ds_write_b64 v8, v[24:25] offset:3616
    ds_write_b64 v8, v[26:27] offset:3744
    ds_write_b64 v8, v[28:29] offset:3872
    ds_write_b64 v8, v[30:31] offset:4000
    ds_write_b64 v8, v[32:33] offset:4128
    ds_write_b64 v8, v[34:35] offset:4256
    ds_write_b64 v8, v[36:37] offset:4384
    v_lshrrev_b32 v9, 2, v3
    v_lshl_add_u32 v9, v4, 3, v9
    v_mul_u32_u24 v9, 904, v9
    v_and_b32 v5, 3, v3
    v_lshl_add_u32 v9, v5, 3, v9
    v_lshl_add_u32 v9, v2, 5, v9
    v_lshl_add_u32 v5, v2, 4, v3
    v_lshlrev_b32 v5, 6, v5
    v_lshl_add_u32 v5, v4, 4, v5
    s_mul_i32 s5, s4, 28672
    s_waitcnt lgkmcnt(0)
    s_barrier
    ds_read_b64_tr_b16 v[10:11], v9 offset:0
    ds_read_b64_tr_b16 v[12:13], v9 offset:3616
    ds_read_b64_tr_b16 v[14:15], v9 offset:128
    ds_read_b64_tr_b16 v[16:17], v9 offset:3744
    ds_read_b64_tr_b16 v[18:19], v9 offset:256
    ds_read_b64_tr_b16 v[20:21], v9 offset:3872
    ds_read_b64_tr_b16 v[22:23], v9 offset:384
    ds_read_b64_tr_b16 v[24:25], v9 offset:4000
    ds_read_b64_tr_b16 v[26:27], v9 offset:512
    ds_read_b64_tr_b16 v[28:29], v9 offset:4128
    ds_read_b64_tr_b16 v[30:31], v9 offset:640
    ds_read_b64_tr_b16 v[32:33], v9 offset:4256
    ds_read_b64_tr_b16 v[34:35], v9 offset:768
    ds_read_b64_tr_b16 v[36:37], v9 offset:4384
    s_waitcnt lgkmcnt(12)
    buffer_store_dwordx4 v[10:13], v5, s[60:63], s5 offen sc1
    s_add_u32 s5, s5, 4096
    s_waitcnt lgkmcnt(10)
    buffer_store_dwordx4 v[14:17], v5, s[60:63], s5 offen sc1
    s_add_u32 s5, s5, 4096
    s_waitcnt lgkmcnt(8)
    buffer_store_dwordx4 v[18:21], v5, s[60:63], s5 offen sc1
    s_add_u32 s5, s5, 4096
    s_waitcnt lgkmcnt(6)
    buffer_store_dwordx4 v[22:25], v5, s[60:63], s5 offen sc1
    s_add_u32 s5, s5, 4096
    s_waitcnt lgkmcnt(4)
    buffer_store_dwordx4 v[26:29], v5, s[60:63], s5 offen sc1
    s_add_u32 s5, s5, 4096
    s_waitcnt lgkmcnt(2)
    buffer_store_dwordx4 v[30:33], v5, s[60:63], s5 offen sc1
    s_add_u32 s5, s5, 4096
    s_waitcnt lgkmcnt(0)
    buffer_store_dwordx4 v[34:37], v5, s[60:63], s5 offen sc1
    s_waitcnt vmcnt(0)
    s_barrier
    s_cmp_lg_u32 s7, 0
    s_cbranch_scc1 ka_kernel_sig1
    v_mov_b32 v104, 1
    v_mov_b32 v105, 0
    s_mov_b64 s[10:11], exec
    s_mov_b64 exec, 1
    global_atomic_add v106, v105, v104, s[50:51] sc0 sc1
    s_waitcnt vmcnt(0)
    v_readfirstlane_b32 s12, v106
    s_mov_b64 exec, s[10:11]
    s_cmp_lg_u32 s12, 105
    s_nop 2
    s_cbranch_scc1 ka_kernel_sig1
    s_mov_b64 exec, 1
    global_store_dword v105, v104, s[50:51] offset:128 sc1
    s_mov_b64 exec, s[10:11]
ka_kernel_sig1:
    s_endpgm
ka_mod:
    s_setprio 3
    s_mov_b32 s56, s46
    s_mov_b32 s57, s47
    s_mov_b32 s58, 2408448
    s_mov_b32 s59, 0x00020000
    s_mov_b32 s60, s52
    s_mov_b32 s61, s53
    s_mov_b32 s62, 43520
    s_mov_b32 s63, 0x00020000
    s_mov_b32 s64, s44
    s_mov_b32 s65, s45
    s_mov_b32 s66, 896
    s_mov_b32 s67, 0x00020000
    v_lshlrev_b32 v5, 1, v0
    buffer_load_ushort v6, v5, s[64:67], 0 offen
    buffer_load_ushort v7, v5, s[64:67], 0 offen offset:512
    v_lshl_add_u32 v8, v2, 2, v4
    v_mul_u32_u24 v9, 5376, v8
    v_lshl_add_u32 v9, v3, 3, v9
    s_lshl_b32 s5, s4, 7
    buffer_load_dwordx2 v[10:11], v9, s[56:59], s5 offen
    s_add_u32 s5, s5, 86016
    buffer_load_dwordx2 v[12:13], v9, s[56:59], s5 offen
    s_add_u32 s5, s5, 86016
    buffer_load_dwordx2 v[14:15], v9, s[56:59], s5 offen
    s_add_u32 s5, s5, 86016
    buffer_load_dwordx2 v[16:17], v9, s[56:59], s5 offen
    s_add_u32 s5, s5, 86016
    buffer_load_dwordx2 v[18:19], v9, s[56:59], s5 offen
    s_add_u32 s5, s5, 86016
    buffer_load_dwordx2 v[20:21], v9, s[56:59], s5 offen
    s_add_u32 s5, s5, 86016
    buffer_load_dwordx2 v[22:23], v9, s[56:59], s5 offen
    s_add_u32 s5, s5, 86016
    buffer_load_dwordx2 v[24:25], v9, s[56:59], s5 offen
    s_add_u32 s5, s5, 86016
    buffer_load_dwordx2 v[26:27], v9, s[56:59], s5 offen
    s_add_u32 s5, s5, 86016
    buffer_load_dwordx2 v[28:29], v9, s[56:59], s5 offen
    s_add_u32 s5, s5, 86016
    buffer_load_dwordx2 v[30:31], v9, s[56:59], s5 offen
    s_add_u32 s5, s5, 86016
    buffer_load_dwordx2 v[32:33], v9, s[56:59], s5 offen
    s_add_u32 s5, s5, 86016
    buffer_load_dwordx2 v[34:35], v9, s[56:59], s5 offen
    s_add_u32 s5, s5, 86016
    buffer_load_dwordx2 v[36:37], v9, s[56:59], s5 offen
    s_add_u32 s5, s5, 86016
    buffer_load_dwordx2 v[38:39], v9, s[56:59], s5 offen
    s_add_u32 s5, s5, 86016
    buffer_load_dwordx2 v[40:41], v9, s[56:59], s5 offen
    s_add_u32 s5, s5, 86016
    buffer_load_dwordx2 v[42:43], v9, s[56:59], s5 offen
    s_add_u32 s5, s5, 86016
    buffer_load_dwordx2 v[44:45], v9, s[56:59], s5 offen
    s_add_u32 s5, s5, 86016
    buffer_load_dwordx2 v[46:47], v9, s[56:59], s5 offen
    s_add_u32 s5, s5, 86016
    buffer_load_dwordx2 v[48:49], v9, s[56:59], s5 offen
    s_add_u32 s5, s5, 86016
    buffer_load_dwordx2 v[50:51], v9, s[56:59], s5 offen
    s_add_u32 s5, s5, 86016
    buffer_load_dwordx2 v[52:53], v9, s[56:59], s5 offen
    s_add_u32 s5, s5, 86016
    buffer_load_dwordx2 v[54:55], v9, s[56:59], s5 offen
    s_add_u32 s5, s5, 86016
    buffer_load_dwordx2 v[56:57], v9, s[56:59], s5 offen
    s_add_u32 s5, s5, 86016
    buffer_load_dwordx2 v[58:59], v9, s[56:59], s5 offen
    s_add_u32 s5, s5, 86016
    buffer_load_dwordx2 v[60:61], v9, s[56:59], s5 offen
    s_add_u32 s5, s5, 86016
    buffer_load_dwordx2 v[62:63], v9, s[56:59], s5 offen
    s_add_u32 s5, s5, 86016
    buffer_load_dwordx2 v[64:65], v9, s[56:59], s5 offen
    s_waitcnt vmcnt(28)
    v_lshlrev_b32 v6, 16, v6
    v_mul_f32 v5, 0xbfb8aa3b, v6
    v_exp_f32 v5, v5
    s_nop 0
    v_add_f32 v5, 1.0, v5
    v_rcp_f32 v5, v5
    s_nop 0
    v_mul_f32 v6, v6, v5
    v_cvt_pk_bf16_f32 v6, 0, v6
    v_lshlrev_b32 v7, 16, v7
    v_mul_f32 v5, 0xbfb8aa3b, v7
    v_exp_f32 v5, v5
    s_nop 0
    v_add_f32 v5, 1.0, v5
    v_rcp_f32 v5, v5
    s_nop 0
    v_mul_f32 v7, v7, v5
    v_cvt_pk_bf16_f32 v7, 0, v7
    v_lshlrev_b32 v5, 2, v0
    ds_write_b32 v5, v6
    ds_write_b32 v5, v7 offset:1024
    v_lshlrev_b32 v5, 2, v8
    s_waitcnt lgkmcnt(0)
    s_barrier
    ds_read_b32 v66, v5 offset:0
    ds_read_b32 v67, v5 offset:64
    ds_read_b32 v68, v5 offset:128
    ds_read_b32 v69, v5 offset:192
    ds_read_b32 v70, v5 offset:256
    ds_read_b32 v71, v5 offset:320
    ds_read_b32 v72, v5 offset:384
    ds_read_b32 v73, v5 offset:448
    ds_read_b32 v74, v5 offset:512
    ds_read_b32 v75, v5 offset:576
    ds_read_b32 v76, v5 offset:640
    ds_read_b32 v77, v5 offset:704
    ds_read_b32 v78, v5 offset:768
    ds_read_b32 v79, v5 offset:832
    ds_read_b32 v80, v5 offset:896
    ds_read_b32 v81, v5 offset:960
    ds_read_b32 v82, v5 offset:1024
    ds_read_b32 v83, v5 offset:1088
    ds_read_b32 v84, v5 offset:1152
    ds_read_b32 v85, v5 offset:1216
    ds_read_b32 v86, v5 offset:1280
    ds_read_b32 v87, v5 offset:1344
    ds_read_b32 v88, v5 offset:1408
    ds_read_b32 v89, v5 offset:1472
    ds_read_b32 v90, v5 offset:1536
    ds_read_b32 v91, v5 offset:1600
    ds_read_b32 v92, v5 offset:1664
    ds_read_b32 v93, v5 offset:1728
    v_mov_b32 v96, 0
    v_mov_b32 v97, 0
    v_mov_b32 v98, 0
    v_mov_b32 v99, 0
    s_waitcnt lgkmcnt(0)
    s_waitcnt vmcnt(27)
    v_lshlrev_b32 v100, 16, v10
    v_and_b32 v101, 0xffff0000, v10
    v_lshlrev_b32 v102, 16, v11
    v_and_b32 v103, 0xffff0000, v11
    v_fmac_f32 v96, v100, v66
    v_fmac_f32 v97, v101, v66
    v_fmac_f32 v98, v102, v66
    v_fmac_f32 v99, v103, v66
    s_waitcnt vmcnt(26)
    v_lshlrev_b32 v100, 16, v12
    v_and_b32 v101, 0xffff0000, v12
    v_lshlrev_b32 v102, 16, v13
    v_and_b32 v103, 0xffff0000, v13
    v_fmac_f32 v96, v100, v67
    v_fmac_f32 v97, v101, v67
    v_fmac_f32 v98, v102, v67
    v_fmac_f32 v99, v103, v67
    s_waitcnt vmcnt(25)
    v_lshlrev_b32 v100, 16, v14
    v_and_b32 v101, 0xffff0000, v14
    v_lshlrev_b32 v102, 16, v15
    v_and_b32 v103, 0xffff0000, v15
    v_fmac_f32 v96, v100, v68
    v_fmac_f32 v97, v101, v68
    v_fmac_f32 v98, v102, v68
    v_fmac_f32 v99, v103, v68
    s_waitcnt vmcnt(24)
    v_lshlrev_b32 v100, 16, v16
    v_and_b32 v101, 0xffff0000, v16
    v_lshlrev_b32 v102, 16, v17
    v_and_b32 v103, 0xffff0000, v17
    v_fmac_f32 v96, v100, v69
    v_fmac_f32 v97, v101, v69
    v_fmac_f32 v98, v102, v69
    v_fmac_f32 v99, v103, v69
    s_waitcnt vmcnt(23)
    v_lshlrev_b32 v100, 16, v18
    v_and_b32 v101, 0xffff0000, v18
    v_lshlrev_b32 v102, 16, v19
    v_and_b32 v103, 0xffff0000, v19
    v_fmac_f32 v96, v100, v70
    v_fmac_f32 v97, v101, v70
    v_fmac_f32 v98, v102, v70
    v_fmac_f32 v99, v103, v70
    s_waitcnt vmcnt(22)
    v_lshlrev_b32 v100, 16, v20
    v_and_b32 v101, 0xffff0000, v20
    v_lshlrev_b32 v102, 16, v21
    v_and_b32 v103, 0xffff0000, v21
    v_fmac_f32 v96, v100, v71
    v_fmac_f32 v97, v101, v71
    v_fmac_f32 v98, v102, v71
    v_fmac_f32 v99, v103, v71
    s_waitcnt vmcnt(21)
    v_lshlrev_b32 v100, 16, v22
    v_and_b32 v101, 0xffff0000, v22
    v_lshlrev_b32 v102, 16, v23
    v_and_b32 v103, 0xffff0000, v23
    v_fmac_f32 v96, v100, v72
    v_fmac_f32 v97, v101, v72
    v_fmac_f32 v98, v102, v72
    v_fmac_f32 v99, v103, v72
    s_waitcnt vmcnt(20)
    v_lshlrev_b32 v100, 16, v24
    v_and_b32 v101, 0xffff0000, v24
    v_lshlrev_b32 v102, 16, v25
    v_and_b32 v103, 0xffff0000, v25
    v_fmac_f32 v96, v100, v73
    v_fmac_f32 v97, v101, v73
    v_fmac_f32 v98, v102, v73
    v_fmac_f32 v99, v103, v73
    s_waitcnt vmcnt(19)
    v_lshlrev_b32 v100, 16, v26
    v_and_b32 v101, 0xffff0000, v26
    v_lshlrev_b32 v102, 16, v27
    v_and_b32 v103, 0xffff0000, v27
    v_fmac_f32 v96, v100, v74
    v_fmac_f32 v97, v101, v74
    v_fmac_f32 v98, v102, v74
    v_fmac_f32 v99, v103, v74
    s_waitcnt vmcnt(18)
    v_lshlrev_b32 v100, 16, v28
    v_and_b32 v101, 0xffff0000, v28
    v_lshlrev_b32 v102, 16, v29
    v_and_b32 v103, 0xffff0000, v29
    v_fmac_f32 v96, v100, v75
    v_fmac_f32 v97, v101, v75
    v_fmac_f32 v98, v102, v75
    v_fmac_f32 v99, v103, v75
    s_waitcnt vmcnt(17)
    v_lshlrev_b32 v100, 16, v30
    v_and_b32 v101, 0xffff0000, v30
    v_lshlrev_b32 v102, 16, v31
    v_and_b32 v103, 0xffff0000, v31
    v_fmac_f32 v96, v100, v76
    v_fmac_f32 v97, v101, v76
    v_fmac_f32 v98, v102, v76
    v_fmac_f32 v99, v103, v76
    s_waitcnt vmcnt(16)
    v_lshlrev_b32 v100, 16, v32
    v_and_b32 v101, 0xffff0000, v32
    v_lshlrev_b32 v102, 16, v33
    v_and_b32 v103, 0xffff0000, v33
    v_fmac_f32 v96, v100, v77
    v_fmac_f32 v97, v101, v77
    v_fmac_f32 v98, v102, v77
    v_fmac_f32 v99, v103, v77
    s_waitcnt vmcnt(15)
    v_lshlrev_b32 v100, 16, v34
    v_and_b32 v101, 0xffff0000, v34
    v_lshlrev_b32 v102, 16, v35
    v_and_b32 v103, 0xffff0000, v35
    v_fmac_f32 v96, v100, v78
    v_fmac_f32 v97, v101, v78
    v_fmac_f32 v98, v102, v78
    v_fmac_f32 v99, v103, v78
    s_waitcnt vmcnt(14)
    v_lshlrev_b32 v100, 16, v36
    v_and_b32 v101, 0xffff0000, v36
    v_lshlrev_b32 v102, 16, v37
    v_and_b32 v103, 0xffff0000, v37
    v_fmac_f32 v96, v100, v79
    v_fmac_f32 v97, v101, v79
    v_fmac_f32 v98, v102, v79
    v_fmac_f32 v99, v103, v79
    s_waitcnt vmcnt(13)
    v_lshlrev_b32 v100, 16, v38
    v_and_b32 v101, 0xffff0000, v38
    v_lshlrev_b32 v102, 16, v39
    v_and_b32 v103, 0xffff0000, v39
    v_fmac_f32 v96, v100, v80
    v_fmac_f32 v97, v101, v80
    v_fmac_f32 v98, v102, v80
    v_fmac_f32 v99, v103, v80
    s_waitcnt vmcnt(12)
    v_lshlrev_b32 v100, 16, v40
    v_and_b32 v101, 0xffff0000, v40
    v_lshlrev_b32 v102, 16, v41
    v_and_b32 v103, 0xffff0000, v41
    v_fmac_f32 v96, v100, v81
    v_fmac_f32 v97, v101, v81
    v_fmac_f32 v98, v102, v81
    v_fmac_f32 v99, v103, v81
    s_waitcnt vmcnt(11)
    v_lshlrev_b32 v100, 16, v42
    v_and_b32 v101, 0xffff0000, v42
    v_lshlrev_b32 v102, 16, v43
    v_and_b32 v103, 0xffff0000, v43
    v_fmac_f32 v96, v100, v82
    v_fmac_f32 v97, v101, v82
    v_fmac_f32 v98, v102, v82
    v_fmac_f32 v99, v103, v82
    s_waitcnt vmcnt(10)
    v_lshlrev_b32 v100, 16, v44
    v_and_b32 v101, 0xffff0000, v44
    v_lshlrev_b32 v102, 16, v45
    v_and_b32 v103, 0xffff0000, v45
    v_fmac_f32 v96, v100, v83
    v_fmac_f32 v97, v101, v83
    v_fmac_f32 v98, v102, v83
    v_fmac_f32 v99, v103, v83
    s_waitcnt vmcnt(9)
    v_lshlrev_b32 v100, 16, v46
    v_and_b32 v101, 0xffff0000, v46
    v_lshlrev_b32 v102, 16, v47
    v_and_b32 v103, 0xffff0000, v47
    v_fmac_f32 v96, v100, v84
    v_fmac_f32 v97, v101, v84
    v_fmac_f32 v98, v102, v84
    v_fmac_f32 v99, v103, v84
    s_waitcnt vmcnt(8)
    v_lshlrev_b32 v100, 16, v48
    v_and_b32 v101, 0xffff0000, v48
    v_lshlrev_b32 v102, 16, v49
    v_and_b32 v103, 0xffff0000, v49
    v_fmac_f32 v96, v100, v85
    v_fmac_f32 v97, v101, v85
    v_fmac_f32 v98, v102, v85
    v_fmac_f32 v99, v103, v85
    s_waitcnt vmcnt(7)
    v_lshlrev_b32 v100, 16, v50
    v_and_b32 v101, 0xffff0000, v50
    v_lshlrev_b32 v102, 16, v51
    v_and_b32 v103, 0xffff0000, v51
    v_fmac_f32 v96, v100, v86
    v_fmac_f32 v97, v101, v86
    v_fmac_f32 v98, v102, v86
    v_fmac_f32 v99, v103, v86
    s_waitcnt vmcnt(6)
    v_lshlrev_b32 v100, 16, v52
    v_and_b32 v101, 0xffff0000, v52
    v_lshlrev_b32 v102, 16, v53
    v_and_b32 v103, 0xffff0000, v53
    v_fmac_f32 v96, v100, v87
    v_fmac_f32 v97, v101, v87
    v_fmac_f32 v98, v102, v87
    v_fmac_f32 v99, v103, v87
    s_waitcnt vmcnt(5)
    v_lshlrev_b32 v100, 16, v54
    v_and_b32 v101, 0xffff0000, v54
    v_lshlrev_b32 v102, 16, v55
    v_and_b32 v103, 0xffff0000, v55
    v_fmac_f32 v96, v100, v88
    v_fmac_f32 v97, v101, v88
    v_fmac_f32 v98, v102, v88
    v_fmac_f32 v99, v103, v88
    s_waitcnt vmcnt(4)
    v_lshlrev_b32 v100, 16, v56
    v_and_b32 v101, 0xffff0000, v56
    v_lshlrev_b32 v102, 16, v57
    v_and_b32 v103, 0xffff0000, v57
    v_fmac_f32 v96, v100, v89
    v_fmac_f32 v97, v101, v89
    v_fmac_f32 v98, v102, v89
    v_fmac_f32 v99, v103, v89
    s_waitcnt vmcnt(3)
    v_lshlrev_b32 v100, 16, v58
    v_and_b32 v101, 0xffff0000, v58
    v_lshlrev_b32 v102, 16, v59
    v_and_b32 v103, 0xffff0000, v59
    v_fmac_f32 v96, v100, v90
    v_fmac_f32 v97, v101, v90
    v_fmac_f32 v98, v102, v90
    v_fmac_f32 v99, v103, v90
    s_waitcnt vmcnt(2)
    v_lshlrev_b32 v100, 16, v60
    v_and_b32 v101, 0xffff0000, v60
    v_lshlrev_b32 v102, 16, v61
    v_and_b32 v103, 0xffff0000, v61
    v_fmac_f32 v96, v100, v91
    v_fmac_f32 v97, v101, v91
    v_fmac_f32 v98, v102, v91
    v_fmac_f32 v99, v103, v91
    s_waitcnt vmcnt(1)
    v_lshlrev_b32 v100, 16, v62
    v_and_b32 v101, 0xffff0000, v62
    v_lshlrev_b32 v102, 16, v63
    v_and_b32 v103, 0xffff0000, v63
    v_fmac_f32 v96, v100, v92
    v_fmac_f32 v97, v101, v92
    v_fmac_f32 v98, v102, v92
    v_fmac_f32 v99, v103, v92
    s_waitcnt vmcnt(0)
    v_lshlrev_b32 v100, 16, v64
    v_and_b32 v101, 0xffff0000, v64
    v_lshlrev_b32 v102, 16, v65
    v_and_b32 v103, 0xffff0000, v65
    v_fmac_f32 v96, v100, v93
    v_fmac_f32 v97, v101, v93
    v_fmac_f32 v98, v102, v93
    v_fmac_f32 v99, v103, v93
    v_lshlrev_b32 v5, 8, v8
    v_lshl_add_u32 v5, v3, 4, v5
    ds_write_b128 v5, v[96:99] offset:2048
    v_lshlrev_b32 v5, 2, v0
    s_waitcnt lgkmcnt(0)
    s_barrier
    s_cmp_lg_u32 s7, 0
    s_cbranch_scc1 ka_kernel_gx2
    ds_read_b32 v10, v5 offset:2048
    ds_read_b32 v11, v5 offset:2304
    ds_read_b32 v12, v5 offset:2560
    ds_read_b32 v13, v5 offset:2816
    ds_read_b32 v14, v5 offset:3072
    ds_read_b32 v15, v5 offset:3328
    ds_read_b32 v16, v5 offset:3584
    ds_read_b32 v17, v5 offset:3840
    ds_read_b32 v18, v5 offset:4096
    ds_read_b32 v19, v5 offset:4352
    ds_read_b32 v20, v5 offset:4608
    ds_read_b32 v21, v5 offset:4864
    ds_read_b32 v22, v5 offset:5120
    ds_read_b32 v23, v5 offset:5376
    ds_read_b32 v24, v5 offset:5632
    ds_read_b32 v25, v5 offset:5888
    s_waitcnt lgkmcnt(0)
    v_add_f32 v10, v10, v18
    v_add_f32 v11, v11, v19
    v_add_f32 v12, v12, v20
    v_add_f32 v13, v13, v21
    v_add_f32 v14, v14, v22
    v_add_f32 v15, v15, v23
    v_add_f32 v16, v16, v24
    v_add_f32 v17, v17, v25
    v_add_f32 v10, v10, v14
    v_add_f32 v11, v11, v15
    v_add_f32 v12, v12, v16
    v_add_f32 v13, v13, v17
    v_add_f32 v10, v10, v12
    v_add_f32 v11, v11, v13
    v_add_f32 v10, v10, v11
    s_lshl_b32 s5, s4, 8
    v_cvt_pk_bf16_f32 v10, 0, v10
    v_add_f32 v11, 1.0, v10
    v_cvt_pk_bf16_f32 v11, 0, v11
    s_add_u32 s6, s5, 32768
    buffer_store_dword v11, v5, s[60:63], s6 offen sc1
    buffer_store_dword v10, v5, s[60:63], s5 offen sc1
    s_waitcnt vmcnt(0)
    s_cmp_lg_u32 s7, 0
    s_cbranch_scc1 ka_kernel_sig3
    v_mov_b32 v104, 1
    v_mov_b32 v105, 0
    s_mov_b64 s[10:11], exec
    s_mov_b64 exec, 1
    global_atomic_add v106, v105, v104, s[50:51] sc0 sc1
    s_waitcnt vmcnt(0)
    v_readfirstlane_b32 s12, v106
    s_mov_b64 exec, s[10:11]
    s_cmp_lg_u32 s12, 105
    s_nop 2
    s_cbranch_scc1 ka_kernel_sig3
    s_mov_b64 exec, 1
    global_store_dword v105, v104, s[50:51] offset:128 sc1
    s_mov_b64 exec, s[10:11]
ka_kernel_sig3:
ka_kernel_gx2:
    s_endpgm
ka_cs:
    s_cmp_lg_u32 s7, 0
    s_cbranch_scc1 ka_kernel_polld6
    v_mov_b32 v20, 0
    s_mov_b32 s12, 0x200000
ka_kernel_poll5:
    global_load_dword v21, v20, s[50:51] offset:128 sc1
    s_waitcnt vmcnt(0)
    v_readfirstlane_b32 s10, v21
    s_sub_u32 s12, s12, 1
    s_cmp_eq_u32 s12, 0
    s_nop 2
    s_cbranch_scc1 ka_kernel_polld6
    s_cmp_lg_u32 s10, 0
    s_cbranch_scc1 ka_kernel_polld6
    s_sleep 4
    s_branch ka_kernel_poll5
ka_kernel_polld6:
    s_barrier
    s_mov_b32 s56, s40
    s_mov_b32 s57, s41
    s_mov_b32 s58, 1605632
    s_mov_b32 s59, 0x00020000
    s_add_u32 s60, s52, 16384
    s_addc_u32 s61, s53, 0
    s_mov_b32 s62, 7168
    s_mov_b32 s63, 0x00020000
    v_lshl_add_u32 v8, v2, 2, v4
    v_mul_u32_u24 v9, 3584, v8
    v_lshl_add_u32 v9, v3, 3, v9
    s_lshl_b32 s5, s4, 7
    buffer_load_dwordx2 v[10:11], v9, s[56:59], s5 offen
    s_add_u32 s5, s5, 57344
    buffer_load_dwordx2 v[12:13], v9, s[56:59], s5 offen
    s_add_u32 s5, s5, 57344
    buffer_load_dwordx2 v[14:15], v9, s[56:59], s5 offen
    s_add_u32 s5, s5, 57344
    buffer_load_dwordx2 v[16:17], v9, s[56:59], s5 offen
    s_add_u32 s5, s5, 57344
    buffer_load_dwordx2 v[18:19], v9, s[56:59], s5 offen
    s_add_u32 s5, s5, 57344
    buffer_load_dwordx2 v[20:21], v9, s[56:59], s5 offen
    s_add_u32 s5, s5, 57344
    buffer_load_dwordx2 v[22:23], v9, s[56:59], s5 offen
    s_add_u32 s5, s5, 57344
    buffer_load_dwordx2 v[24:25], v9, s[56:59], s5 offen
    s_add_u32 s5, s5, 57344
    buffer_load_dwordx2 v[26:27], v9, s[56:59], s5 offen
    s_add_u32 s5, s5, 57344
    buffer_load_dwordx2 v[28:29], v9, s[56:59], s5 offen
    s_add_u32 s5, s5, 57344
    buffer_load_dwordx2 v[30:31], v9, s[56:59], s5 offen
    s_add_u32 s5, s5, 57344
    buffer_load_dwordx2 v[32:33], v9, s[56:59], s5 offen
    s_add_u32 s5, s5, 57344
    buffer_load_dwordx2 v[34:35], v9, s[56:59], s5 offen
    s_add_u32 s5, s5, 57344
    buffer_load_dwordx2 v[36:37], v9, s[56:59], s5 offen
    s_add_u32 s5, s5, 57344
    buffer_load_dwordx2 v[38:39], v9, s[56:59], s5 offen
    s_add_u32 s5, s5, 57344
    buffer_load_dwordx2 v[40:41], v9, s[56:59], s5 offen
    s_add_u32 s5, s5, 57344
    buffer_load_dwordx2 v[42:43], v9, s[56:59], s5 offen
    s_add_u32 s5, s5, 57344
    buffer_load_dwordx2 v[44:45], v9, s[56:59], s5 offen
    s_add_u32 s5, s5, 57344
    buffer_load_dwordx2 v[46:47], v9, s[56:59], s5 offen
    s_add_u32 s5, s5, 57344
    buffer_load_dwordx2 v[48:49], v9, s[56:59], s5 offen
    s_add_u32 s5, s5, 57344
    buffer_load_dwordx2 v[50:51], v9, s[56:59], s5 offen
    s_add_u32 s5, s5, 57344
    buffer_load_dwordx2 v[52:53], v9, s[56:59], s5 offen
    s_add_u32 s5, s5, 57344
    buffer_load_dwordx2 v[54:55], v9, s[56:59], s5 offen
    s_add_u32 s5, s5, 57344
    buffer_load_dwordx2 v[56:57], v9, s[56:59], s5 offen
    s_add_u32 s5, s5, 57344
    buffer_load_dwordx2 v[58:59], v9, s[56:59], s5 offen
    s_add_u32 s5, s5, 57344
    buffer_load_dwordx2 v[60:61], v9, s[56:59], s5 offen
    s_add_u32 s5, s5, 57344
    buffer_load_dwordx2 v[62:63], v9, s[56:59], s5 offen
    s_add_u32 s5, s5, 57344
    buffer_load_dwordx2 v[64:65], v9, s[56:59], s5 offen
    v_mov_b32 v96, 0
    v_mov_b32 v97, 0
    v_mov_b32 v98, 0
    v_mov_b32 v99, 0
    s_waitcnt lgkmcnt(0)
    s_waitcnt vmcnt(27)
    v_lshlrev_b32 v100, 16, v10
    v_and_b32 v101, 0xffff0000, v10
    v_lshlrev_b32 v102, 16, v11
    v_and_b32 v103, 0xffff0000, v11
    v_add_f32 v96, v96, v100
    v_add_f32 v97, v97, v101
    v_add_f32 v98, v98, v102
    v_add_f32 v99, v99, v103
    s_waitcnt vmcnt(26)
    v_lshlrev_b32 v100, 16, v12
    v_and_b32 v101, 0xffff0000, v12
    v_lshlrev_b32 v102, 16, v13
    v_and_b32 v103, 0xffff0000, v13
    v_add_f32 v96, v96, v100
    v_add_f32 v97, v97, v101
    v_add_f32 v98, v98, v102
    v_add_f32 v99, v99, v103
    s_waitcnt vmcnt(25)
    v_lshlrev_b32 v100, 16, v14
    v_and_b32 v101, 0xffff0000, v14
    v_lshlrev_b32 v102, 16, v15
    v_and_b32 v103, 0xffff0000, v15
    v_add_f32 v96, v96, v100
    v_add_f32 v97, v97, v101
    v_add_f32 v98, v98, v102
    v_add_f32 v99, v99, v103
    s_waitcnt vmcnt(24)
    v_lshlrev_b32 v100, 16, v16
    v_and_b32 v101, 0xffff0000, v16
    v_lshlrev_b32 v102, 16, v17
    v_and_b32 v103, 0xffff0000, v17
    v_add_f32 v96, v96, v100
    v_add_f32 v97, v97, v101
    v_add_f32 v98, v98, v102
    v_add_f32 v99, v99, v103
    s_waitcnt vmcnt(23)
    v_lshlrev_b32 v100, 16, v18
    v_and_b32 v101, 0xffff0000, v18
    v_lshlrev_b32 v102, 16, v19
    v_and_b32 v103, 0xffff0000, v19
    v_add_f32 v96, v96, v100
    v_add_f32 v97, v97, v101
    v_add_f32 v98, v98, v102
    v_add_f32 v99, v99, v103
    s_waitcnt vmcnt(22)
    v_lshlrev_b32 v100, 16, v20
    v_and_b32 v101, 0xffff0000, v20
    v_lshlrev_b32 v102, 16, v21
    v_and_b32 v103, 0xffff0000, v21
    v_add_f32 v96, v96, v100
    v_add_f32 v97, v97, v101
    v_add_f32 v98, v98, v102
    v_add_f32 v99, v99, v103
    s_waitcnt vmcnt(21)
    v_lshlrev_b32 v100, 16, v22
    v_and_b32 v101, 0xffff0000, v22
    v_lshlrev_b32 v102, 16, v23
    v_and_b32 v103, 0xffff0000, v23
    v_add_f32 v96, v96, v100
    v_add_f32 v97, v97, v101
    v_add_f32 v98, v98, v102
    v_add_f32 v99, v99, v103
    s_waitcnt vmcnt(20)
    v_lshlrev_b32 v100, 16, v24
    v_and_b32 v101, 0xffff0000, v24
    v_lshlrev_b32 v102, 16, v25
    v_and_b32 v103, 0xffff0000, v25
    v_add_f32 v96, v96, v100
    v_add_f32 v97, v97, v101
    v_add_f32 v98, v98, v102
    v_add_f32 v99, v99, v103
    s_waitcnt vmcnt(19)
    v_lshlrev_b32 v100, 16, v26
    v_and_b32 v101, 0xffff0000, v26
    v_lshlrev_b32 v102, 16, v27
    v_and_b32 v103, 0xffff0000, v27
    v_add_f32 v96, v96, v100
    v_add_f32 v97, v97, v101
    v_add_f32 v98, v98, v102
    v_add_f32 v99, v99, v103
    s_waitcnt vmcnt(18)
    v_lshlrev_b32 v100, 16, v28
    v_and_b32 v101, 0xffff0000, v28
    v_lshlrev_b32 v102, 16, v29
    v_and_b32 v103, 0xffff0000, v29
    v_add_f32 v96, v96, v100
    v_add_f32 v97, v97, v101
    v_add_f32 v98, v98, v102
    v_add_f32 v99, v99, v103
    s_waitcnt vmcnt(17)
    v_lshlrev_b32 v100, 16, v30
    v_and_b32 v101, 0xffff0000, v30
    v_lshlrev_b32 v102, 16, v31
    v_and_b32 v103, 0xffff0000, v31
    v_add_f32 v96, v96, v100
    v_add_f32 v97, v97, v101
    v_add_f32 v98, v98, v102
    v_add_f32 v99, v99, v103
    s_waitcnt vmcnt(16)
    v_lshlrev_b32 v100, 16, v32
    v_and_b32 v101, 0xffff0000, v32
    v_lshlrev_b32 v102, 16, v33
    v_and_b32 v103, 0xffff0000, v33
    v_add_f32 v96, v96, v100
    v_add_f32 v97, v97, v101
    v_add_f32 v98, v98, v102
    v_add_f32 v99, v99, v103
    s_waitcnt vmcnt(15)
    v_lshlrev_b32 v100, 16, v34
    v_and_b32 v101, 0xffff0000, v34
    v_lshlrev_b32 v102, 16, v35
    v_and_b32 v103, 0xffff0000, v35
    v_add_f32 v96, v96, v100
    v_add_f32 v97, v97, v101
    v_add_f32 v98, v98, v102
    v_add_f32 v99, v99, v103
    s_waitcnt vmcnt(14)
    v_lshlrev_b32 v100, 16, v36
    v_and_b32 v101, 0xffff0000, v36
    v_lshlrev_b32 v102, 16, v37
    v_and_b32 v103, 0xffff0000, v37
    v_add_f32 v96, v96, v100
    v_add_f32 v97, v97, v101
    v_add_f32 v98, v98, v102
    v_add_f32 v99, v99, v103
    s_waitcnt vmcnt(13)
    v_lshlrev_b32 v100, 16, v38
    v_and_b32 v101, 0xffff0000, v38
    v_lshlrev_b32 v102, 16, v39
    v_and_b32 v103, 0xffff0000, v39
    v_add_f32 v96, v96, v100
    v_add_f32 v97, v97, v101
    v_add_f32 v98, v98, v102
    v_add_f32 v99, v99, v103
    s_waitcnt vmcnt(12)
    v_lshlrev_b32 v100, 16, v40
    v_and_b32 v101, 0xffff0000, v40
    v_lshlrev_b32 v102, 16, v41
    v_and_b32 v103, 0xffff0000, v41
    v_add_f32 v96, v96, v100
    v_add_f32 v97, v97, v101
    v_add_f32 v98, v98, v102
    v_add_f32 v99, v99, v103
    s_waitcnt vmcnt(11)
    v_lshlrev_b32 v100, 16, v42
    v_and_b32 v101, 0xffff0000, v42
    v_lshlrev_b32 v102, 16, v43
    v_and_b32 v103, 0xffff0000, v43
    v_add_f32 v96, v96, v100
    v_add_f32 v97, v97, v101
    v_add_f32 v98, v98, v102
    v_add_f32 v99, v99, v103
    s_waitcnt vmcnt(10)
    v_lshlrev_b32 v100, 16, v44
    v_and_b32 v101, 0xffff0000, v44
    v_lshlrev_b32 v102, 16, v45
    v_and_b32 v103, 0xffff0000, v45
    v_add_f32 v96, v96, v100
    v_add_f32 v97, v97, v101
    v_add_f32 v98, v98, v102
    v_add_f32 v99, v99, v103
    s_waitcnt vmcnt(9)
    v_lshlrev_b32 v100, 16, v46
    v_and_b32 v101, 0xffff0000, v46
    v_lshlrev_b32 v102, 16, v47
    v_and_b32 v103, 0xffff0000, v47
    v_add_f32 v96, v96, v100
    v_add_f32 v97, v97, v101
    v_add_f32 v98, v98, v102
    v_add_f32 v99, v99, v103
    s_waitcnt vmcnt(8)
    v_lshlrev_b32 v100, 16, v48
    v_and_b32 v101, 0xffff0000, v48
    v_lshlrev_b32 v102, 16, v49
    v_and_b32 v103, 0xffff0000, v49
    v_add_f32 v96, v96, v100
    v_add_f32 v97, v97, v101
    v_add_f32 v98, v98, v102
    v_add_f32 v99, v99, v103
    s_waitcnt vmcnt(7)
    v_lshlrev_b32 v100, 16, v50
    v_and_b32 v101, 0xffff0000, v50
    v_lshlrev_b32 v102, 16, v51
    v_and_b32 v103, 0xffff0000, v51
    v_add_f32 v96, v96, v100
    v_add_f32 v97, v97, v101
    v_add_f32 v98, v98, v102
    v_add_f32 v99, v99, v103
    s_waitcnt vmcnt(6)
    v_lshlrev_b32 v100, 16, v52
    v_and_b32 v101, 0xffff0000, v52
    v_lshlrev_b32 v102, 16, v53
    v_and_b32 v103, 0xffff0000, v53
    v_add_f32 v96, v96, v100
    v_add_f32 v97, v97, v101
    v_add_f32 v98, v98, v102
    v_add_f32 v99, v99, v103
    s_waitcnt vmcnt(5)
    v_lshlrev_b32 v100, 16, v54
    v_and_b32 v101, 0xffff0000, v54
    v_lshlrev_b32 v102, 16, v55
    v_and_b32 v103, 0xffff0000, v55
    v_add_f32 v96, v96, v100
    v_add_f32 v97, v97, v101
    v_add_f32 v98, v98, v102
    v_add_f32 v99, v99, v103
    s_waitcnt vmcnt(4)
    v_lshlrev_b32 v100, 16, v56
    v_and_b32 v101, 0xffff0000, v56
    v_lshlrev_b32 v102, 16, v57
    v_and_b32 v103, 0xffff0000, v57
    v_add_f32 v96, v96, v100
    v_add_f32 v97, v97, v101
    v_add_f32 v98, v98, v102
    v_add_f32 v99, v99, v103
    s_waitcnt vmcnt(3)
    v_lshlrev_b32 v100, 16, v58
    v_and_b32 v101, 0xffff0000, v58
    v_lshlrev_b32 v102, 16, v59
    v_and_b32 v103, 0xffff0000, v59
    v_add_f32 v96, v96, v100
    v_add_f32 v97, v97, v101
    v_add_f32 v98, v98, v102
    v_add_f32 v99, v99, v103
    s_waitcnt vmcnt(2)
    v_lshlrev_b32 v100, 16, v60
    v_and_b32 v101, 0xffff0000, v60
    v_lshlrev_b32 v102, 16, v61
    v_and_b32 v103, 0xffff0000, v61
    v_add_f32 v96, v96, v100
    v_add_f32 v97, v97, v101
    v_add_f32 v98, v98, v102
    v_add_f32 v99, v99, v103
    s_waitcnt vmcnt(1)
    v_lshlrev_b32 v100, 16, v62
    v_and_b32 v101, 0xffff0000, v62
    v_lshlrev_b32 v102, 16, v63
    v_and_b32 v103, 0xffff0000, v63
    v_add_f32 v96, v96, v100
    v_add_f32 v97, v97, v101
    v_add_f32 v98, v98, v102
    v_add_f32 v99, v99, v103
    s_waitcnt vmcnt(0)
    v_lshlrev_b32 v100, 16, v64
    v_and_b32 v101, 0xffff0000, v64
    v_lshlrev_b32 v102, 16, v65
    v_and_b32 v103, 0xffff0000, v65
    v_add_f32 v96, v96, v100
    v_add_f32 v97, v97, v101
    v_add_f32 v98, v98, v102
    v_add_f32 v99, v99, v103
    v_lshlrev_b32 v5, 8, v8
    v_lshl_add_u32 v5, v3, 4, v5
    ds_write_b128 v5, v[96:99] offset:2048
    v_lshlrev_b32 v5, 2, v0
    s_waitcnt lgkmcnt(0)
    s_barrier
    s_cmp_lg_u32 s7, 0
    s_cbranch_scc1 ka_kernel_gx4
    ds_read_b32 v10, v5 offset:2048
    ds_read_b32 v11, v5 offset:2304
    ds_read_b32 v12, v5 offset:2560
    ds_read_b32 v13, v5 offset:2816
    ds_read_b32 v14, v5 offset:3072
    ds_read_b32 v15, v5 offset:3328
    ds_read_b32 v16, v5 offset:3584
    ds_read_b32 v17, v5 offset:3840
    ds_read_b32 v18, v5 offset:4096
    ds_read_b32 v19, v5 offset:4352
    ds_read_b32 v20, v5 offset:4608
    ds_read_b32 v21, v5 offset:4864
    ds_read_b32 v22, v5 offset:5120
    ds_read_b32 v23, v5 offset:5376
    ds_read_b32 v24, v5 offset:5632
    ds_read_b32 v25, v5 offset:5888
    s_waitcnt lgkmcnt(0)
    v_add_f32 v10, v10, v18
    v_add_f32 v11, v11, v19
    v_add_f32 v12, v12, v20
    v_add_f32 v13, v13, v21
    v_add_f32 v14, v14, v22
    v_add_f32 v15, v15, v23
    v_add_f32 v16, v16, v24
    v_add_f32 v17, v17, v25
    v_add_f32 v10, v10, v14
    v_add_f32 v11, v11, v15
    v_add_f32 v12, v12, v16
    v_add_f32 v13, v13, v17
    v_add_f32 v10, v10, v12
    v_add_f32 v11, v11, v13
    v_add_f32 v10, v10, v11
    s_lshl_b32 s5, s4, 8
    buffer_store_dword v10, v5, s[60:63], s5 offen
ka_kernel_gx4:
    s_endpgm
ka_rp:
    s_cmp_lg_u32 s7, 0
    s_cbranch_scc1 ka_kernel_polld12
    v_mov_b32 v20, 0
    s_mov_b32 s12, 0x200000
ka_kernel_poll11:
    global_load_dword v21, v20, s[50:51] offset:128 sc1
    s_waitcnt vmcnt(0)
    v_readfirstlane_b32 s10, v21
    s_sub_u32 s12, s12, 1
    s_cmp_eq_u32 s12, 0
    s_nop 2
    s_cbranch_scc1 ka_kernel_polld12
    s_cmp_lg_u32 s10, 0
    s_cbranch_scc1 ka_kernel_polld12
    s_sleep 4
    s_branch ka_kernel_poll11
ka_kernel_polld12:
    s_barrier
    s_cmp_ge_u32 s4, 84
    s_cbranch_scc1 ka_kernel_rp9
    s_cmp_ge_u32 s4, 28
    s_cbranch_scc1 ka_kernel_rp8
    s_cmp_ge_u32 s4, 14
    s_cbranch_scc1 ka_kernel_rp7
    s_mov_b32 s56, s36
    s_mov_b32 s57, s37
    s_mov_b32 s58, 401408
    s_mov_b32 s59, 0x00020000
    s_mov_b32 s6, 896
    s_mul_i32 s5, s4, 28672
    s_mul_i32 s8, s4, 7168
    s_add_u32 s8, s8, 26214400
    s_mov_b32 s9, 100352
    s_branch ka_kernel_rp10
ka_kernel_rp7:
    s_mov_b32 s56, s38
    s_mov_b32 s57, s39
    s_mov_b32 s58, 401408
    s_mov_b32 s59, 0x00020000
    s_sub_u32 s4, s4, 14
    s_mov_b32 s6, 896
    s_mul_i32 s5, s4, 28672
    s_mul_i32 s8, s4, 7168
    s_add_u32 s8, s8, 26738688
    s_mov_b32 s9, 100352
    s_branch ka_kernel_rp10
ka_kernel_rp8:
    s_mov_b32 s56, s42
    s_mov_b32 s57, s43
    s_mov_b32 s58, 1605632
    s_mov_b32 s59, 0x00020000
    s_sub_u32 s4, s4, 28
    s_mov_b32 s6, 896
    s_mul_i32 s5, s4, 28672
    s_mul_i32 s8, s4, 7168
    s_add_u32 s8, s8, 29360128
    s_mov_b32 s9, 401408
    s_branch ka_kernel_rp10
ka_kernel_rp9:
    s_mov_b32 s56, s40
    s_mov_b32 s57, s41
    s_mov_b32 s58, 1605632
    s_mov_b32 s59, 0x00020000
    s_sub_u32 s4, s4, 84
    s_and_b32 s10, s4, 3
    s_lshr_b32 s4, s4, 2
    s_mov_b32 s6, 3584
    s_mul_i32 s5, s4, 114688
    s_mul_i32 s11, s10, 896
    s_add_u32 s5, s5, s11
    s_mul_i32 s8, s4, 7168
    s_mul_i32 s11, s10, 401408
    s_add_u32 s8, s8, s11
    s_add_u32 s8, s8, 27262976
    s_mov_b32 s9, 100352
ka_kernel_rp10:
    s_mov_b32 s60, s52
    s_mov_b32 s61, s53
    s_mov_b32 s62, 31457280
    s_mov_b32 s63, 0x00020000
    s_sub_u32 s10, s2, 134
    s_cmp_ge_u32 s10, 24
    s_cbranch_scc1 ka_kernel_z13
    s_lshl_b32 s10, s10, 10
    s_add_u32 s10, s10, 262144
    v_lshlrev_b32 v5, 2, v0
    v_mov_b32 v6, 0
    buffer_store_dword v6, v5, s[60:63], s10 offen
ka_kernel_z13:
    s_lshl_b32 s10, s7, 10
    v_add_u32 v5, 0, v0
    v_mul_u32_u24 v6, 18725, v5
    v_lshrrev_b32 v6, 20, v6
    v_mul_u32_u24 v7, 56, v6
    v_sub_u32 v7, v5, v7
    v_mul_lo_u32 v6, v6, s6
    v_lshl_add_u32 v6, v7, 4, v6
    s_add_u32 m0, s10, 0
    s_nop 0
    buffer_load_dwordx4 v6, s[56:59], s5 offen lds
    v_add_u32 v5, 256, v0
    v_mul_u32_u24 v6, 18725, v5
    v_lshrrev_b32 v6, 20, v6
    v_mul_u32_u24 v7, 56, v6
    v_sub_u32 v7, v5, v7
    v_mul_lo_u32 v6, v6, s6
    v_lshl_add_u32 v6, v7, 4, v6
    s_add_u32 m0, s10, 4096
    s_nop 0
    buffer_load_dwordx4 v6, s[56:59], s5 offen lds
    v_add_u32 v5, 512, v0
    v_mul_u32_u24 v6, 18725, v5
    v_lshrrev_b32 v6, 20, v6
    v_mul_u32_u24 v7, 56, v6
    v_sub_u32 v7, v5, v7
    v_mul_lo_u32 v6, v6, s6
    v_lshl_add_u32 v6, v7, 4, v6
    s_add_u32 m0, s10, 8192
    s_nop 0
    buffer_load_dwordx4 v6, s[56:59], s5 offen lds
    v_add_u32 v5, 768, v0
    v_mul_u32_u24 v6, 18725, v5
    v_lshrrev_b32 v6, 20, v6
    v_mul_u32_u24 v7, 56, v6
    v_sub_u32 v7, v5, v7
    v_mul_lo_u32 v6, v6, s6
    v_lshl_add_u32 v6, v7, 4, v6
    s_add_u32 m0, s10, 12288
    s_nop 0
    buffer_load_dwordx4 v6, s[56:59], s5 offen lds
    v_add_u32 v5, 1024, v0
    v_mul_u32_u24 v6, 18725, v5
    v_lshrrev_b32 v6, 20, v6
    v_mul_u32_u24 v7, 56, v6
    v_sub_u32 v7, v5, v7
    v_mul_lo_u32 v6, v6, s6
    v_lshl_add_u32 v6, v7, 4, v6
    s_add_u32 m0, s10, 16384
    s_nop 0
    buffer_load_dwordx4 v6, s[56:59], s5 offen lds
    v_add_u32 v5, 1280, v0
    v_mul_u32_u24 v6, 18725, v5
    v_lshrrev_b32 v6, 20, v6
    v_mul_u32_u24 v7, 56, v6
    v_sub_u32 v7, v5, v7
    v_mul_lo_u32 v6, v6, s6
    v_lshl_add_u32 v6, v7, 4, v6
    s_add_u32 m0, s10, 20480
    s_nop 0
    buffer_load_dwordx4 v6, s[56:59], s5 offen lds
    v_add_u32 v5, 1536, v0
    v_mul_u32_u24 v6, 18725, v5
    v_lshrrev_b32 v6, 20, v6
    v_mul_u32_u24 v7, 56, v6
    v_sub_u32 v7, v5, v7
    v_mul_lo_u32 v6, v6, s6
    v_lshl_add_u32 v6, v7, 4, v6
    s_add_u32 m0, s10, 24576
    s_nop 0
    buffer_load_dwordx4 v6, s[56:59], s5 offen lds
    v_lshrrev_b32 v5, 2, v3
    v_lshl_add_u32 v5, v4, 3, v5
    v_mul_u32_u24 v5, 896, v5
    v_and_b32 v6, 3, v3
    v_lshl_add_u32 v5, v6, 3, v5
    v_mul_u32_u24 v6, 224, v2
    v_add_u32 v5, v5, v6
    v_lshlrev_b32 v6, 4, v1
    s_mul_i32 s9, s9, s7
    s_add_u32 s8, s8, s9
    s_waitcnt vmcnt(0)
    s_barrier
    ds_read_b64_tr_b16 v[10:11], v5 offset:0
    ds_read_b64_tr_b16 v[12:13], v5 offset:3584
    ds_read_b64_tr_b16 v[14:15], v5 offset:32
    ds_read_b64_tr_b16 v[16:17], v5 offset:3616
    ds_read_b64_tr_b16 v[18:19], v5 offset:64
    ds_read_b64_tr_b16 v[20:21], v5 offset:3648
    ds_read_b64_tr_b16 v[22:23], v5 offset:96
    ds_read_b64_tr_b16 v[24:25], v5 offset:3680
    ds_read_b64_tr_b16 v[26:27], v5 offset:128
    ds_read_b64_tr_b16 v[28:29], v5 offset:3712
    ds_read_b64_tr_b16 v[30:31], v5 offset:160
    ds_read_b64_tr_b16 v[32:33], v5 offset:3744
    ds_read_b64_tr_b16 v[34:35], v5 offset:192
    ds_read_b64_tr_b16 v[36:37], v5 offset:3776
    s_waitcnt lgkmcnt(12)
    buffer_store_dwordx4 v[10:13], v6, s[60:63], s8 offen offset:0 sc1
    s_waitcnt lgkmcnt(10)
    buffer_store_dwordx4 v[14:17], v6, s[60:63], s8 offen offset:1024 sc1
    s_waitcnt lgkmcnt(8)
    buffer_store_dwordx4 v[18:21], v6, s[60:63], s8 offen offset:2048 sc1
    s_waitcnt lgkmcnt(6)
    buffer_store_dwordx4 v[22:25], v6, s[60:63], s8 offen offset:3072 sc1
    s_waitcnt lgkmcnt(4)
    s_add_u32 s8, s8, 4096
    buffer_store_dwordx4 v[26:29], v6, s[60:63], s8 offen offset:0 sc1
    s_waitcnt lgkmcnt(2)
    buffer_store_dwordx4 v[30:33], v6, s[60:63], s8 offen offset:1024 sc1
    s_waitcnt lgkmcnt(0)
    buffer_store_dwordx4 v[34:37], v6, s[60:63], s8 offen offset:2048 sc1
    s_endpgm
ka_ssm:
    s_cmp_ge_u32 s2, 512
    s_cbranch_scc1 ka_kernel_skew14
    s_setprio 2
ka_kernel_skew14:
    s_and_b32 s5, s4, 7
    s_mul_i32 s5, s5, 56
    s_lshr_b32 s4, s4, 3
    s_add_u32 s4, s4, s5
    s_lshl_b32 s5, s4, 9
    v_lshl_add_u32 v5, v0, 1, s5
    s_and_b32 s6, s4, 0xfffffffe
    s_lshl_b32 s6, s6, 1
    s_waitcnt lgkmcnt(0)
    global_load_ushort v10, v5, s[18:19]
    global_load_ushort v11, v5, s[20:21]
    global_load_ushort v12, v5, s[22:23]
    global_load_ushort v13, v5, s[24:25]
    global_load_ushort v14, v5, s[26:27]
    global_load_ushort v15, v5, s[28:29]
    s_add_u32 s8, s30, s6
    s_addc_u32 s9, s31, 0
    s_load_dword s10, s[8:9], 0
    s_add_u32 s8, s32, s6
    s_addc_u32 s9, s33, 0
    s_load_dword s15, s[8:9], 0
    v_mul_u32_u24 v6, 8704, v2
    v_lshl_add_u32 v7, v1, 2, v6
    v_add_u32 v100, 0, v7
    v_add_u32 v101, 1088, v7
    v_add_u32 v102, 2176, v7
    v_add_u32 v103, 3264, v7
    v_add_u32 v104, 4352, v7
    v_add_u32 v105, 5440, v7
    v_add_u32 v106, 6528, v7
    v_add_u32 v107, 7616, v7
    v_mul_u32_u24 v8, 544, v3
    v_add_u32 v8, v8, v6
    v_lshl_add_u32 v8, v4, 4, v8
    v_mov_b32 v160, 0xffff0000
    v_mov_b32 v161, 0x07060302
    s_waitcnt lgkmcnt(0)
    s_and_b32 s11, s4, 1
    s_lshl_b32 s11, s11, 4
    s_lshr_b32 s10, s10, s11
    s_lshl_b32 s10, s10, 16
    s_lshr_b32 s15, s15, s11
    s_lshl_b32 s15, s15, 16
    v_mov_b32 v9, s10
    v_mul_f32 v9, 0x3fb8aa3b, v9
    v_exp_f32 v9, v9
    s_nop 0
    v_cvt_pk_bf16_f32 v9, 0, v9
    s_waitcnt vmcnt(0)
    v_lshlrev_b32 v10, 16, v10
    v_lshlrev_b32 v11, 16, v11
    v_lshlrev_b32 v12, 16, v12
    v_lshlrev_b32 v13, 16, v13
    v_lshlrev_b32 v14, 16, v14
    v_lshlrev_b32 v15, 16, v15
    v_mul_f32 v10, v9, v10
    v_mul_f32 v11, v9, v11
    v_mul_f32 v12, v9, v12
    v_mul_f32 v13, v9, v13
    v_mul_f32 v16, v14, v12
    v_mul_f32 v17, v14, v13
    v_fma_f32 v16, -v15, v13, v16
    v_fmac_f32 v17, v15, v12
    v_mul_f32 v42, 0x3fb8aa3b, v10
    v_mul_f32 v43, 0x3e22f983, v11
    v_exp_f32 v42, v42
    v_fract_f32 v43, v43
    v_cos_f32 v20, v43
    v_sin_f32 v21, v43
    v_mul_f32 v20, v20, v42
    v_mul_f32 v21, v21, v42
    v_mul_f32 v44, 0x4138aa3b, v10
    v_mul_f32 v45, 0xbfa2f983, v11
    v_exp_f32 v44, v44
    v_fract_f32 v45, v45
    v_cos_f32 v34, v45
    v_sin_f32 v35, v45
    v_mul_f32 v34, v34, v44
    v_mul_f32 v35, v35, v44
    v_mul_f32 v46, 0x4338aa3b, v10
    v_mul_f32 v47, 0x41a2f983, v11
    v_exp_f32 v46, v46
    v_fract_f32 v47, v47
    v_cos_f32 v38, v47
    v_sin_f32 v39, v47
    v_mul_f32 v38, v38, v46
    v_mul_f32 v39, v39, v46
    v_mul_f32 v36, v34, v34
    v_mul_f32 v37, v34, v35
    v_fma_f32 v36, -v35, v35, v36
    v_fmac_f32 v37, v35, v34
    v_mov_b32 v48, 0x3f80
    v_mov_b32 v49, 0
    ds_write2_b32 v100, v48, v49 offset0:0 offset1:68
    v_and_b32 v53, v160, v34
    v_and_b32 v54, v160, v35
    v_perm_b32 v52, v35, v34, v161
    v_sub_f32 v53, v34, v53
    v_sub_f32 v54, v35, v54
    v_cvt_pk_bf16_f32 v55, v53, v54
    ds_write2_b32 v100, v52, v55 offset0:136 offset1:204
    v_and_b32 v49, v160, v36
    v_and_b32 v50, v160, v37
    v_perm_b32 v48, v37, v36, v161
    v_sub_f32 v49, v36, v49
    v_sub_f32 v50, v37, v50
    v_cvt_pk_bf16_f32 v51, v49, v50
    ds_write2_b32 v101, v48, v51 offset0:0 offset1:68
    v_mul_f32 v56, v34, v36
    v_mul_f32 v57, v34, v37
    v_fma_f32 v56, -v35, v37, v56
    v_fmac_f32 v57, v35, v36
    v_and_b32 v53, v160, v56
    v_and_b32 v54, v160, v57
    v_perm_b32 v52, v57, v56, v161
    v_sub_f32 v53, v56, v53
    v_sub_f32 v54, v57, v54
    v_cvt_pk_bf16_f32 v55, v53, v54
    ds_write2_b32 v101, v52, v55 offset0:136 offset1:204
    v_mul_f32 v58, v36, v36
    v_mul_f32 v59, v36, v37
    v_fma_f32 v58, -v37, v37, v58
    v_fmac_f32 v59, v37, v36
    v_and_b32 v49, v160, v58
    v_and_b32 v50, v160, v59
    v_perm_b32 v48, v59, v58, v161
    v_sub_f32 v49, v58, v49
    v_sub_f32 v50, v59, v50
    v_cvt_pk_bf16_f32 v51, v49, v50
    ds_write2_b32 v102, v48, v51 offset0:0 offset1:68
    v_mul_f32 v60, v56, v36
    v_mul_f32 v61, v56, v37
    v_fma_f32 v60, -v57, v37, v60
    v_fmac_f32 v61, v57, v36
    v_and_b32 v53, v160, v60
    v_and_b32 v54, v160, v61
    v_perm_b32 v52, v61, v60, v161
    v_sub_f32 v53, v60, v53
    v_sub_f32 v54, v61, v54
    v_cvt_pk_bf16_f32 v55, v53, v54
    ds_write2_b32 v102, v52, v55 offset0:136 offset1:204
    v_mul_f32 v62, v58, v36
    v_mul_f32 v63, v58, v37
    v_fma_f32 v62, -v59, v37, v62
    v_fmac_f32 v63, v59, v36
    v_and_b32 v49, v160, v62
    v_and_b32 v50, v160, v63
    v_perm_b32 v48, v63, v62, v161
    v_sub_f32 v49, v62, v49
    v_sub_f32 v50, v63, v50
    v_cvt_pk_bf16_f32 v51, v49, v50
    ds_write2_b32 v103, v48, v51 offset0:0 offset1:68
    v_mul_f32 v56, v60, v36
    v_mul_f32 v57, v60, v37
    v_fma_f32 v56, -v61, v37, v56
    v_fmac_f32 v57, v61, v36
    v_and_b32 v53, v160, v56
    v_and_b32 v54, v160, v57
    v_perm_b32 v52, v57, v56, v161
    v_sub_f32 v53, v56, v53
    v_sub_f32 v54, v57, v54
    v_cvt_pk_bf16_f32 v55, v53, v54
    ds_write2_b32 v103, v52, v55 offset0:136 offset1:204
    v_mul_f32 v58, v62, v36
    v_mul_f32 v59, v62, v37
    v_fma_f32 v58, -v63, v37, v58
    v_fmac_f32 v59, v63, v36
    v_and_b32 v49, v160, v58
    v_and_b32 v50, v160, v59
    v_perm_b32 v48, v59, v58, v161
    v_sub_f32 v49, v58, v49
    v_sub_f32 v50, v59, v50
    v_cvt_pk_bf16_f32 v51, v49, v50
    ds_write2_b32 v104, v48, v51 offset0:0 offset1:68
    v_mul_f32 v60, v56, v36
    v_mul_f32 v61, v56, v37
    v_fma_f32 v60, -v57, v37, v60
    v_fmac_f32 v61, v57, v36
    v_and_b32 v53, v160, v60
    v_and_b32 v54, v160, v61
    v_perm_b32 v52, v61, v60, v161
    v_sub_f32 v53, v60, v53
    v_sub_f32 v54, v61, v54
    v_cvt_pk_bf16_f32 v55, v53, v54
    ds_write2_b32 v104, v52, v55 offset0:136 offset1:204
    v_mul_f32 v62, v58, v36
    v_mul_f32 v63, v58, v37
    v_fma_f32 v62, -v59, v37, v62
    v_fmac_f32 v63, v59, v36
    v_and_b32 v49, v160, v62
    v_and_b32 v50, v160, v63
    v_perm_b32 v48, v63, v62, v161
    v_sub_f32 v49, v62, v49
    v_sub_f32 v50, v63, v50
    v_cvt_pk_bf16_f32 v51, v49, v50
    ds_write2_b32 v105, v48, v51 offset0:0 offset1:68
    v_mul_f32 v56, v60, v36
    v_mul_f32 v57, v60, v37
    v_fma_f32 v56, -v61, v37, v56
    v_fmac_f32 v57, v61, v36
    v_and_b32 v53, v160, v56
    v_and_b32 v54, v160, v57
    v_perm_b32 v52, v57, v56, v161
    v_sub_f32 v53, v56, v53
    v_sub_f32 v54, v57, v54
    v_cvt_pk_bf16_f32 v55, v53, v54
    ds_write2_b32 v105, v52, v55 offset0:136 offset1:204
    v_mul_f32 v58, v62, v36
    v_mul_f32 v59, v62, v37
    v_fma_f32 v58, -v63, v37, v58
    v_fmac_f32 v59, v63, v36
    v_and_b32 v49, v160, v58
    v_and_b32 v50, v160, v59
    v_perm_b32 v48, v59, v58, v161
    v_sub_f32 v49, v58, v49
    v_sub_f32 v50, v59, v50
    v_cvt_pk_bf16_f32 v51, v49, v50
    ds_write2_b32 v106, v48, v51 offset0:0 offset1:68
    v_mul_f32 v60, v56, v36
    v_mul_f32 v61, v56, v37
    v_fma_f32 v60, -v57, v37, v60
    v_fmac_f32 v61, v57, v36
    v_and_b32 v53, v160, v60
    v_and_b32 v54, v160, v61
    v_perm_b32 v52, v61, v60, v161
    v_sub_f32 v53, v60, v53
    v_sub_f32 v54, v61, v54
    v_cvt_pk_bf16_f32 v55, v53, v54
    ds_write2_b32 v106, v52, v55 offset0:136 offset1:204
    v_mul_f32 v62, v58, v36
    v_mul_f32 v63, v58, v37
    v_fma_f32 v62, -v59, v37, v62
    v_fmac_f32 v63, v59, v36
    v_and_b32 v49, v160, v62
    v_and_b32 v50, v160, v63
    v_perm_b32 v48, v63, v62, v161
    v_sub_f32 v49, v62, v49
    v_sub_f32 v50, v63, v50
    v_cvt_pk_bf16_f32 v51, v49, v50
    ds_write2_b32 v107, v48, v51 offset0:0 offset1:68
    v_mul_f32 v56, v60, v36
    v_mul_f32 v57, v60, v37
    v_fma_f32 v56, -v61, v37, v56
    v_fmac_f32 v57, v61, v36
    v_and_b32 v53, v160, v56
    v_and_b32 v54, v160, v57
    v_perm_b32 v52, v57, v56, v161
    v_sub_f32 v53, v56, v53
    v_sub_f32 v54, v57, v54
    v_cvt_pk_bf16_f32 v55, v53, v54
    ds_write2_b32 v107, v52, v55 offset0:136 offset1:204
    v_mul_f32 v22, v20, v20
    v_mul_f32 v23, v20, v21
    v_fma_f32 v22, -v21, v21, v22
    v_fmac_f32 v23, v21, v20
    v_mul_f32 v24, v22, v20
    v_mul_f32 v25, v22, v21
    v_fma_f32 v24, -v23, v21, v24
    v_fmac_f32 v25, v23, v20
    v_mul_f32 v26, v22, v22
    v_mul_f32 v27, v22, v23
    v_fma_f32 v26, -v23, v23, v26
    v_fmac_f32 v27, v23, v22
    v_mul_f32 v28, v26, v20
    v_mul_f32 v29, v26, v21
    v_fma_f32 v28, -v27, v21, v28
    v_fmac_f32 v29, v27, v20
    v_mul_f32 v30, v26, v22
    v_mul_f32 v31, v26, v23
    v_fma_f32 v30, -v27, v23, v30
    v_fmac_f32 v31, v27, v22
    v_mul_f32 v32, v26, v24
    v_mul_f32 v33, v26, v25
    v_fma_f32 v32, -v27, v25, v32
    v_fmac_f32 v33, v27, v24
    v_mul_f32 v40, v38, v38
    v_mul_f32 v41, v38, v39
    v_fma_f32 v40, -v39, v39, v40
    v_fmac_f32 v41, v39, v38
    s_waitcnt lgkmcnt(0)
    ds_read_b128 v[64:67], v8 offset:0
    ds_read_b128 v[68:71], v8 offset:64
    ds_read_b128 v[72:75], v8 offset:128
    ds_read_b128 v[76:79], v8 offset:192
    ds_read_b128 v[80:83], v8 offset:272
    ds_read_b128 v[84:87], v8 offset:336
    ds_read_b128 v[88:91], v8 offset:400
    ds_read_b128 v[92:95], v8 offset:464
    v_mov_b32 v140, 0
    v_mov_b32 v141, 0
    v_mov_b32 v142, 0
    v_mov_b32 v143, 0
    v_mov_b32 v144, 0
    v_mov_b32 v145, 0
    v_mov_b32 v146, 0
    v_mov_b32 v147, 0
    v_mov_b32 v148, 0
    v_mov_b32 v149, 0
    v_mov_b32 v150, 0
    v_mov_b32 v151, 0
    s_waitcnt lgkmcnt(0)
    v_and_b32 v49, v160, v16
    v_and_b32 v50, v160, v17
    v_perm_b32 v48, v17, v16, v161
    v_sub_f32 v49, v16, v49
    v_sub_f32 v50, v17, v50
    v_cvt_pk_bf16_f32 v51, v49, v50
    ds_write2_b32 v100, v48, v51 offset0:0 offset1:68
    v_mul_f32 v58, v16, v20
    v_mul_f32 v59, v16, v21
    v_fma_f32 v58, -v17, v21, v58
    v_fmac_f32 v59, v17, v20
    v_and_b32 v53, v160, v58
    v_and_b32 v54, v160, v59
    v_perm_b32 v52, v59, v58, v161
    v_sub_f32 v53, v58, v53
    v_sub_f32 v54, v59, v54
    v_cvt_pk_bf16_f32 v55, v53, v54
    ds_write2_b32 v100, v52, v55 offset0:136 offset1:204
    v_mul_f32 v60, v16, v22
    v_mul_f32 v61, v16, v23
    v_fma_f32 v60, -v17, v23, v60
    v_fmac_f32 v61, v17, v22
    v_and_b32 v49, v160, v60
    v_and_b32 v50, v160, v61
    v_perm_b32 v48, v61, v60, v161
    v_sub_f32 v49, v60, v49
    v_sub_f32 v50, v61, v50
    v_cvt_pk_bf16_f32 v51, v49, v50
    ds_write2_b32 v101, v48, v51 offset0:0 offset1:68
    v_mul_f32 v62, v16, v24
    v_mul_f32 v63, v16, v25
    v_fma_f32 v62, -v17, v25, v62
    v_fmac_f32 v63, v17, v24
    v_and_b32 v53, v160, v62
    v_and_b32 v54, v160, v63
    v_perm_b32 v52, v63, v62, v161
    v_sub_f32 v53, v62, v53
    v_sub_f32 v54, v63, v54
    v_cvt_pk_bf16_f32 v55, v53, v54
    ds_write2_b32 v101, v52, v55 offset0:136 offset1:204
    v_mul_f32 v56, v16, v26
    v_mul_f32 v57, v16, v27
    v_fma_f32 v56, -v17, v27, v56
    v_fmac_f32 v57, v17, v26
    v_and_b32 v49, v160, v56
    v_and_b32 v50, v160, v57
    v_perm_b32 v48, v57, v56, v161
    v_sub_f32 v49, v56, v49
    v_sub_f32 v50, v57, v50
    v_cvt_pk_bf16_f32 v51, v49, v50
    ds_write2_b32 v102, v48, v51 offset0:0 offset1:68
    v_mul_f32 v58, v16, v28
    v_mul_f32 v59, v16, v29
    v_fma_f32 v58, -v17, v29, v58
    v_fmac_f32 v59, v17, v28
    v_and_b32 v53, v160, v58
    v_and_b32 v54, v160, v59
    v_perm_b32 v52, v59, v58, v161
    v_sub_f32 v53, v58, v53
    v_sub_f32 v54, v59, v54
    v_cvt_pk_bf16_f32 v55, v53, v54
    ds_write2_b32 v102, v52, v55 offset0:136 offset1:204
    v_mul_f32 v60, v16, v30
    v_mul_f32 v61, v16, v31
    v_fma_f32 v60, -v17, v31, v60
    v_fmac_f32 v61, v17, v30
    v_and_b32 v49, v160, v60
    v_and_b32 v50, v160, v61
    v_perm_b32 v48, v61, v60, v161
    v_sub_f32 v49, v60, v49
    v_sub_f32 v50, v61, v50
    v_cvt_pk_bf16_f32 v51, v49, v50
    ds_write2_b32 v103, v48, v51 offset0:0 offset1:68
    v_mul_f32 v62, v16, v32
    v_mul_f32 v63, v16, v33
    v_fma_f32 v62, -v17, v33, v62
    v_fmac_f32 v63, v17, v32
    v_and_b32 v53, v160, v62
    v_and_b32 v54, v160, v63
    v_perm_b32 v52, v63, v62, v161
    v_sub_f32 v53, v62, v53
    v_sub_f32 v54, v63, v54
    v_cvt_pk_bf16_f32 v55, v53, v54
    ds_write2_b32 v103, v52, v55 offset0:136 offset1:204
    v_mul_f32 v152, v16, v38
    v_mul_f32 v153, v16, v39
    v_fma_f32 v152, -v17, v39, v152
    v_fmac_f32 v153, v17, v38
    v_and_b32 v49, v160, v152
    v_and_b32 v50, v160, v153
    v_perm_b32 v48, v153, v152, v161
    v_sub_f32 v49, v152, v49
    v_sub_f32 v50, v153, v50
    v_cvt_pk_bf16_f32 v51, v49, v50
    ds_write2_b32 v104, v48, v51 offset0:0 offset1:68
    v_mul_f32 v56, v152, v20
    v_mul_f32 v57, v152, v21
    v_fma_f32 v56, -v153, v21, v56
    v_fmac_f32 v57, v153, v20
    v_and_b32 v53, v160, v56
    v_and_b32 v54, v160, v57
    v_perm_b32 v52, v57, v56, v161
    v_sub_f32 v53, v56, v53
    v_sub_f32 v54, v57, v54
    v_cvt_pk_bf16_f32 v55, v53, v54
    ds_write2_b32 v104, v52, v55 offset0:136 offset1:204
    v_mul_f32 v58, v152, v22
    v_mul_f32 v59, v152, v23
    v_fma_f32 v58, -v153, v23, v58
    v_fmac_f32 v59, v153, v22
    v_and_b32 v49, v160, v58
    v_and_b32 v50, v160, v59
    v_perm_b32 v48, v59, v58, v161
    v_sub_f32 v49, v58, v49
    v_sub_f32 v50, v59, v50
    v_cvt_pk_bf16_f32 v51, v49, v50
    ds_write2_b32 v105, v48, v51 offset0:0 offset1:68
    v_mul_f32 v60, v152, v24
    v_mul_f32 v61, v152, v25
    v_fma_f32 v60, -v153, v25, v60
    v_fmac_f32 v61, v153, v24
    v_and_b32 v53, v160, v60
    v_and_b32 v54, v160, v61
    v_perm_b32 v52, v61, v60, v161
    v_sub_f32 v53, v60, v53
    v_sub_f32 v54, v61, v54
    v_cvt_pk_bf16_f32 v55, v53, v54
    ds_write2_b32 v105, v52, v55 offset0:136 offset1:204
    v_mul_f32 v62, v152, v26
    v_mul_f32 v63, v152, v27
    v_fma_f32 v62, -v153, v27, v62
    v_fmac_f32 v63, v153, v26
    v_and_b32 v49, v160, v62
    v_and_b32 v50, v160, v63
    v_perm_b32 v48, v63, v62, v161
    v_sub_f32 v49, v62, v49
    v_sub_f32 v50, v63, v50
    v_cvt_pk_bf16_f32 v51, v49, v50
    ds_write2_b32 v106, v48, v51 offset0:0 offset1:68
    v_mul_f32 v56, v152, v28
    v_mul_f32 v57, v152, v29
    v_fma_f32 v56, -v153, v29, v56
    v_fmac_f32 v57, v153, v28
    v_and_b32 v53, v160, v56
    v_and_b32 v54, v160, v57
    v_perm_b32 v52, v57, v56, v161
    v_sub_f32 v53, v56, v53
    v_sub_f32 v54, v57, v54
    v_cvt_pk_bf16_f32 v55, v53, v54
    ds_write2_b32 v106, v52, v55 offset0:136 offset1:204
    v_mul_f32 v58, v152, v30
    v_mul_f32 v59, v152, v31
    v_fma_f32 v58, -v153, v31, v58
    v_fmac_f32 v59, v153, v30
    v_and_b32 v49, v160, v58
    v_and_b32 v50, v160, v59
    v_perm_b32 v48, v59, v58, v161
    v_sub_f32 v49, v58, v49
    v_sub_f32 v50, v59, v50
    v_cvt_pk_bf16_f32 v51, v49, v50
    ds_write2_b32 v107, v48, v51 offset0:0 offset1:68
    v_mul_f32 v60, v152, v32
    v_mul_f32 v61, v152, v33
    v_fma_f32 v60, -v153, v33, v60
    v_fmac_f32 v61, v153, v32
    v_and_b32 v53, v160, v60
    v_and_b32 v54, v160, v61
    v_perm_b32 v52, v61, v60, v161
    v_sub_f32 v53, v60, v53
    v_sub_f32 v54, v61, v54
    v_cvt_pk_bf16_f32 v55, v53, v54
    ds_write2_b32 v107, v52, v55 offset0:136 offset1:204
    s_waitcnt lgkmcnt(0)
    ds_read_b128 v[108:111], v8 offset:0
    ds_read_b128 v[112:115], v8 offset:64
    ds_read_b128 v[116:119], v8 offset:128
    ds_read_b128 v[120:123], v8 offset:192
    ds_read_b128 v[124:127], v8 offset:272
    ds_read_b128 v[128:131], v8 offset:336
    ds_read_b128 v[132:135], v8 offset:400
    ds_read_b128 v[136:139], v8 offset:464
    s_waitcnt lgkmcnt(7)
    v_mfma_f32_16x16x32_bf16 v[140:143], v[108:111], v[64:67], v[140:143]
    s_waitcnt lgkmcnt(6)
    v_mfma_f32_16x16x32_bf16 v[140:143], v[112:115], v[68:71], v[140:143]
    s_waitcnt lgkmcnt(5)
    v_mfma_f32_16x16x32_bf16 v[140:143], v[116:119], v[72:75], v[140:143]
    s_waitcnt lgkmcnt(4)
    v_mfma_f32_16x16x32_bf16 v[140:143], v[120:123], v[76:79], v[140:143]
    v_mfma_f32_16x16x32_bf16 v[140:143], v[108:111], v[80:83], v[140:143]
    v_mfma_f32_16x16x32_bf16 v[140:143], v[112:115], v[84:87], v[140:143]
    v_mfma_f32_16x16x32_bf16 v[140:143], v[116:119], v[88:91], v[140:143]
    v_mfma_f32_16x16x32_bf16 v[140:143], v[120:123], v[92:95], v[140:143]
    s_waitcnt lgkmcnt(0)
    v_mfma_f32_16x16x32_bf16 v[140:143], v[124:127], v[64:67], v[140:143]
    v_mfma_f32_16x16x32_bf16 v[140:143], v[128:131], v[68:71], v[140:143]
    v_mfma_f32_16x16x32_bf16 v[140:143], v[132:135], v[72:75], v[140:143]
    v_mfma_f32_16x16x32_bf16 v[140:143], v[136:139], v[76:79], v[140:143]
    v_mul_f32 v154, v16, v40
    v_mul_f32 v155, v16, v41
    v_fma_f32 v154, -v17, v41, v154
    v_fmac_f32 v155, v17, v40
    v_and_b32 v49, v160, v154
    v_and_b32 v50, v160, v155
    v_perm_b32 v48, v155, v154, v161
    v_sub_f32 v49, v154, v49
    v_sub_f32 v50, v155, v50
    v_cvt_pk_bf16_f32 v51, v49, v50
    ds_write2_b32 v100, v48, v51 offset0:0 offset1:68
    v_mul_f32 v62, v154, v22
    v_mul_f32 v63, v154, v23
    v_fma_f32 v62, -v155, v23, v62
    v_fmac_f32 v63, v155, v22
    v_and_b32 v53, v160, v62
    v_and_b32 v54, v160, v63
    v_perm_b32 v52, v63, v62, v161
    v_sub_f32 v53, v62, v53
    v_sub_f32 v54, v63, v54
    v_cvt_pk_bf16_f32 v55, v53, v54
    ds_write2_b32 v100, v52, v55 offset0:136 offset1:204
    v_mul_f32 v56, v154, v26
    v_mul_f32 v57, v154, v27
    v_fma_f32 v56, -v155, v27, v56
    v_fmac_f32 v57, v155, v26
    v_and_b32 v49, v160, v56
    v_and_b32 v50, v160, v57
    v_perm_b32 v48, v57, v56, v161
    v_sub_f32 v49, v56, v49
    v_sub_f32 v50, v57, v50
    v_cvt_pk_bf16_f32 v51, v49, v50
    ds_write2_b32 v101, v48, v51 offset0:0 offset1:68
    v_mul_f32 v58, v154, v30
    v_mul_f32 v59, v154, v31
    v_fma_f32 v58, -v155, v31, v58
    v_fmac_f32 v59, v155, v30
    v_and_b32 v53, v160, v58
    v_and_b32 v54, v160, v59
    v_perm_b32 v52, v59, v58, v161
    v_sub_f32 v53, v58, v53
    v_sub_f32 v54, v59, v54
    v_cvt_pk_bf16_f32 v55, v53, v54
    ds_write2_b32 v101, v52, v55 offset0:136 offset1:204
    v_mul_f32 v156, v152, v40
    v_mul_f32 v157, v152, v41
    v_fma_f32 v156, -v153, v41, v156
    v_fmac_f32 v157, v153, v40
    v_and_b32 v49, v160, v156
    v_and_b32 v50, v160, v157
    v_perm_b32 v48, v157, v156, v161
    v_sub_f32 v49, v156, v49
    v_sub_f32 v50, v157, v50
    v_cvt_pk_bf16_f32 v51, v49, v50
    ds_write2_b32 v102, v48, v51 offset0:0 offset1:68
    v_mul_f32 v60, v156, v22
    v_mul_f32 v61, v156, v23
    v_fma_f32 v60, -v157, v23, v60
    v_fmac_f32 v61, v157, v22
    v_and_b32 v53, v160, v60
    v_and_b32 v54, v160, v61
    v_perm_b32 v52, v61, v60, v161
    v_sub_f32 v53, v60, v53
    v_sub_f32 v54, v61, v54
    v_cvt_pk_bf16_f32 v55, v53, v54
    ds_write2_b32 v102, v52, v55 offset0:136 offset1:204
    v_mul_f32 v62, v156, v26
    v_mul_f32 v63, v156, v27
    v_fma_f32 v62, -v157, v27, v62
    v_fmac_f32 v63, v157, v26
    v_and_b32 v49, v160, v62
    v_and_b32 v50, v160, v63
    v_perm_b32 v48, v63, v62, v161
    v_sub_f32 v49, v62, v49
    v_sub_f32 v50, v63, v50
    v_cvt_pk_bf16_f32 v51, v49, v50
    ds_write2_b32 v103, v48, v51 offset0:0 offset1:68
    v_mul_f32 v56, v156, v30
    v_mul_f32 v57, v156, v31
    v_fma_f32 v56, -v157, v31, v56
    v_fmac_f32 v57, v157, v30
    v_and_b32 v53, v160, v56
    v_and_b32 v54, v160, v57
    v_perm_b32 v52, v57, v56, v161
    v_sub_f32 v53, v56, v53
    v_sub_f32 v54, v57, v54
    v_cvt_pk_bf16_f32 v55, v53, v54
    ds_write2_b32 v103, v52, v55 offset0:136 offset1:204
    v_mul_f32 v158, v154, v40
    v_mul_f32 v159, v154, v41
    v_fma_f32 v158, -v155, v41, v158
    v_fmac_f32 v159, v155, v40
    v_and_b32 v49, v160, v158
    v_and_b32 v50, v160, v159
    v_perm_b32 v48, v159, v158, v161
    v_sub_f32 v49, v158, v49
    v_sub_f32 v50, v159, v50
    v_cvt_pk_bf16_f32 v51, v49, v50
    ds_write2_b32 v104, v48, v51 offset0:0 offset1:68
    v_mul_f32 v58, v158, v26
    v_mul_f32 v59, v158, v27
    v_fma_f32 v58, -v159, v27, v58
    v_fmac_f32 v59, v159, v26
    v_and_b32 v53, v160, v58
    v_and_b32 v54, v160, v59
    v_perm_b32 v52, v59, v58, v161
    v_sub_f32 v53, v58, v53
    v_sub_f32 v54, v59, v54
    v_cvt_pk_bf16_f32 v55, v53, v54
    ds_write2_b32 v104, v52, v55 offset0:136 offset1:204
    v_mul_f32 v152, v156, v40
    v_mul_f32 v153, v156, v41
    v_fma_f32 v152, -v157, v41, v152
    v_fmac_f32 v153, v157, v40
    v_and_b32 v49, v160, v152
    v_and_b32 v50, v160, v153
    v_perm_b32 v48, v153, v152, v161
    v_sub_f32 v49, v152, v49
    v_sub_f32 v50, v153, v50
    v_cvt_pk_bf16_f32 v51, v49, v50
    ds_write2_b32 v105, v48, v51 offset0:0 offset1:68
    v_mul_f32 v60, v152, v26
    v_mul_f32 v61, v152, v27
    v_fma_f32 v60, -v153, v27, v60
    v_fmac_f32 v61, v153, v26
    v_and_b32 v53, v160, v60
    v_and_b32 v54, v160, v61
    v_perm_b32 v52, v61, v60, v161
    v_sub_f32 v53, v60, v53
    v_sub_f32 v54, v61, v54
    v_cvt_pk_bf16_f32 v55, v53, v54
    ds_write2_b32 v105, v52, v55 offset0:136 offset1:204
    v_mul_f32 v154, v158, v40
    v_mul_f32 v155, v158, v41
    v_fma_f32 v154, -v159, v41, v154
    v_fmac_f32 v155, v159, v40
    v_and_b32 v49, v160, v154
    v_and_b32 v50, v160, v155
    v_perm_b32 v48, v155, v154, v161
    v_sub_f32 v49, v154, v49
    v_sub_f32 v50, v155, v50
    v_cvt_pk_bf16_f32 v51, v49, v50
    ds_write2_b32 v106, v48, v51 offset0:0 offset1:68
    v_mul_f32 v62, v154, v26
    v_mul_f32 v63, v154, v27
    v_fma_f32 v62, -v155, v27, v62
    v_fmac_f32 v63, v155, v26
    v_and_b32 v53, v160, v62
    v_and_b32 v54, v160, v63
    v_perm_b32 v52, v63, v62, v161
    v_sub_f32 v53, v62, v53
    v_sub_f32 v54, v63, v54
    v_cvt_pk_bf16_f32 v55, v53, v54
    ds_write2_b32 v106, v52, v55 offset0:136 offset1:204
    v_mul_f32 v156, v152, v40
    v_mul_f32 v157, v152, v41
    v_fma_f32 v156, -v153, v41, v156
    v_fmac_f32 v157, v153, v40
    v_and_b32 v49, v160, v156
    v_and_b32 v50, v160, v157
    v_perm_b32 v48, v157, v156, v161
    v_sub_f32 v49, v156, v49
    v_sub_f32 v50, v157, v50
    v_cvt_pk_bf16_f32 v51, v49, v50
    ds_write2_b32 v107, v48, v51 offset0:0 offset1:68
    v_mul_f32 v56, v156, v26
    v_mul_f32 v57, v156, v27
    v_fma_f32 v56, -v157, v27, v56
    v_fmac_f32 v57, v157, v26
    v_and_b32 v53, v160, v56
    v_and_b32 v54, v160, v57
    v_perm_b32 v52, v57, v56, v161
    v_sub_f32 v53, v56, v53
    v_sub_f32 v54, v57, v54
    v_cvt_pk_bf16_f32 v55, v53, v54
    ds_write2_b32 v107, v52, v55 offset0:136 offset1:204
    s_waitcnt lgkmcnt(0)
    ds_read_b128 v[108:111], v8 offset:0
    ds_read_b128 v[112:115], v8 offset:64
    ds_read_b128 v[116:119], v8 offset:128
    ds_read_b128 v[120:123], v8 offset:192
    ds_read_b128 v[124:127], v8 offset:272
    ds_read_b128 v[128:131], v8 offset:336
    ds_read_b128 v[132:135], v8 offset:400
    ds_read_b128 v[136:139], v8 offset:464
    s_waitcnt lgkmcnt(7)
    v_mfma_f32_16x16x32_bf16 v[144:147], v[108:111], v[64:67], v[144:147]
    s_waitcnt lgkmcnt(6)
    v_mfma_f32_16x16x32_bf16 v[144:147], v[112:115], v[68:71], v[144:147]
    s_waitcnt lgkmcnt(5)
    v_mfma_f32_16x16x32_bf16 v[144:147], v[116:119], v[72:75], v[144:147]
    s_waitcnt lgkmcnt(4)
    v_mfma_f32_16x16x32_bf16 v[144:147], v[120:123], v[76:79], v[144:147]
    v_mfma_f32_16x16x32_bf16 v[144:147], v[108:111], v[80:83], v[144:147]
    v_mfma_f32_16x16x32_bf16 v[144:147], v[112:115], v[84:87], v[144:147]
    v_mfma_f32_16x16x32_bf16 v[144:147], v[116:119], v[88:91], v[144:147]
    v_mfma_f32_16x16x32_bf16 v[144:147], v[120:123], v[92:95], v[144:147]
    s_waitcnt lgkmcnt(0)
    v_mfma_f32_16x16x32_bf16 v[144:147], v[124:127], v[64:67], v[144:147]
    v_mfma_f32_16x16x32_bf16 v[144:147], v[128:131], v[68:71], v[144:147]
    v_mfma_f32_16x16x32_bf16 v[144:147], v[132:135], v[72:75], v[144:147]
    v_mfma_f32_16x16x32_bf16 v[144:147], v[136:139], v[76:79], v[144:147]
    v_mul_f32 v158, v154, v40
    v_mul_f32 v159, v154, v41
    v_fma_f32 v158, -v155, v41, v158
    v_fmac_f32 v159, v155, v40
    v_and_b32 v49, v160, v158
    v_and_b32 v50, v160, v159
    v_perm_b32 v48, v159, v158, v161
    v_sub_f32 v49, v158, v49
    v_sub_f32 v50, v159, v50
    v_cvt_pk_bf16_f32 v51, v49, v50
    ds_write2_b32 v100, v48, v51 offset0:0 offset1:68
    v_mul_f32 v152, v156, v40
    v_mul_f32 v153, v156, v41
    v_fma_f32 v152, -v157, v41, v152
    v_fmac_f32 v153, v157, v40
    v_and_b32 v53, v160, v152
    v_and_b32 v54, v160, v153
    v_perm_b32 v52, v153, v152, v161
    v_sub_f32 v53, v152, v53
    v_sub_f32 v54, v153, v54
    v_cvt_pk_bf16_f32 v55, v53, v54
    ds_write2_b32 v100, v52, v55 offset0:136 offset1:204
    v_mul_f32 v154, v158, v40
    v_mul_f32 v155, v158, v41
    v_fma_f32 v154, -v159, v41, v154
    v_fmac_f32 v155, v159, v40
    v_and_b32 v49, v160, v154
    v_and_b32 v50, v160, v155
    v_perm_b32 v48, v155, v154, v161
    v_sub_f32 v49, v154, v49
    v_sub_f32 v50, v155, v50
    v_cvt_pk_bf16_f32 v51, v49, v50
    ds_write2_b32 v101, v48, v51 offset0:0 offset1:68
    v_mul_f32 v156, v152, v40
    v_mul_f32 v157, v152, v41
    v_fma_f32 v156, -v153, v41, v156
    v_fmac_f32 v157, v153, v40
    v_and_b32 v53, v160, v156
    v_and_b32 v54, v160, v157
    v_perm_b32 v52, v157, v156, v161
    v_sub_f32 v53, v156, v53
    v_sub_f32 v54, v157, v54
    v_cvt_pk_bf16_f32 v55, v53, v54
    ds_write2_b32 v101, v52, v55 offset0:136 offset1:204
    v_mul_f32 v158, v154, v40
    v_mul_f32 v159, v154, v41
    v_fma_f32 v158, -v155, v41, v158
    v_fmac_f32 v159, v155, v40
    v_and_b32 v49, v160, v158
    v_and_b32 v50, v160, v159
    v_perm_b32 v48, v159, v158, v161
    v_sub_f32 v49, v158, v49
    v_sub_f32 v50, v159, v50
    v_cvt_pk_bf16_f32 v51, v49, v50
    ds_write2_b32 v102, v48, v51 offset0:0 offset1:68
    v_mul_f32 v152, v156, v40
    v_mul_f32 v153, v156, v41
    v_fma_f32 v152, -v157, v41, v152
    v_fmac_f32 v153, v157, v40
    v_and_b32 v53, v160, v152
    v_and_b32 v54, v160, v153
    v_perm_b32 v52, v153, v152, v161
    v_sub_f32 v53, v152, v53
    v_sub_f32 v54, v153, v54
    v_cvt_pk_bf16_f32 v55, v53, v54
    ds_write2_b32 v102, v52, v55 offset0:136 offset1:204
    v_mul_f32 v154, v158, v40
    v_mul_f32 v155, v158, v41
    v_fma_f32 v154, -v159, v41, v154
    v_fmac_f32 v155, v159, v40
    v_and_b32 v49, v160, v154
    v_and_b32 v50, v160, v155
    v_perm_b32 v48, v155, v154, v161
    v_sub_f32 v49, v154, v49
    v_sub_f32 v50, v155, v50
    v_cvt_pk_bf16_f32 v51, v49, v50
    ds_write2_b32 v103, v48, v51 offset0:0 offset1:68
    v_mul_f32 v156, v152, v40
    v_mul_f32 v157, v152, v41
    v_fma_f32 v156, -v153, v41, v156
    v_fmac_f32 v157, v153, v40
    v_and_b32 v53, v160, v156
    v_and_b32 v54, v160, v157
    v_perm_b32 v52, v157, v156, v161
    v_sub_f32 v53, v156, v53
    v_sub_f32 v54, v157, v54
    v_cvt_pk_bf16_f32 v55, v53, v54
    ds_write2_b32 v103, v52, v55 offset0:136 offset1:204
    v_mul_f32 v158, v154, v40
    v_mul_f32 v159, v154, v41
    v_fma_f32 v158, -v155, v41, v158
    v_fmac_f32 v159, v155, v40
    v_and_b32 v49, v160, v158
    v_and_b32 v50, v160, v159
    v_perm_b32 v48, v159, v158, v161
    v_sub_f32 v49, v158, v49
    v_sub_f32 v50, v159, v50
    v_cvt_pk_bf16_f32 v51, v49, v50
    ds_write2_b32 v104, v48, v51 offset0:0 offset1:68
    s_waitcnt lgkmcnt(0)
    ds_read_b128 v[108:111], v8 offset:0
    ds_read_b128 v[112:115], v8 offset:64
    ds_read_b128 v[116:119], v8 offset:128
    ds_read_b128 v[120:123], v8 offset:192
    ds_read_b128 v[124:127], v8 offset:272
    ds_read_b128 v[128:131], v8 offset:336
    ds_read_b128 v[132:135], v8 offset:400
    ds_read_b128 v[136:139], v8 offset:464
    s_waitcnt lgkmcnt(7)
    v_mfma_f32_16x16x32_bf16 v[148:151], v[108:111], v[64:67], v[148:151]
    s_waitcnt lgkmcnt(6)
    v_mfma_f32_16x16x32_bf16 v[148:151], v[112:115], v[68:71], v[148:151]
    s_waitcnt lgkmcnt(5)
    v_mfma_f32_16x16x32_bf16 v[148:151], v[116:119], v[72:75], v[148:151]
    s_waitcnt lgkmcnt(4)
    v_mfma_f32_16x16x32_bf16 v[148:151], v[120:123], v[76:79], v[148:151]
    v_mfma_f32_16x16x32_bf16 v[148:151], v[108:111], v[80:83], v[148:151]
    v_mfma_f32_16x16x32_bf16 v[148:151], v[112:115], v[84:87], v[148:151]
    v_mfma_f32_16x16x32_bf16 v[148:151], v[116:119], v[88:91], v[148:151]
    v_mfma_f32_16x16x32_bf16 v[148:151], v[120:123], v[92:95], v[148:151]
    s_waitcnt lgkmcnt(0)
    v_mfma_f32_16x16x32_bf16 v[148:151], v[124:127], v[64:67], v[148:151]
    v_mfma_f32_16x16x32_bf16 v[148:151], v[128:131], v[68:71], v[148:151]
    v_mfma_f32_16x16x32_bf16 v[148:151], v[132:135], v[72:75], v[148:151]
    v_mfma_f32_16x16x32_bf16 v[148:151], v[136:139], v[76:79], v[148:151]
    v_and_b32 v10, 1, v4
    v_lshrrev_b32 v11, 1, v4
    v_lshlrev_b32 v12, 4, v10
    v_lshl_add_u32 v12, v11, 9, v12
    v_lshl_add_u32 v12, v3, 5, v12
    v_add_u32 v12, v12, v6
    v_lshlrev_b32 v13, 8, v10
    v_lshl_add_u32 v14, v3, 4, v13
    v_add_u32 v14, 1024, v14
    v_lshl_add_u32 v15, v3, 3, v13
    v_add_u32 v15, 1536, v15
    v_cmp_gt_u32 vcc, 2, v4
    s_nop 1
    v_cndmask_b32 v14, v15, v14, vcc
    v_mov_b32 v15, 128
    v_cndmask_b32 v15, v15, 8, vcc
    v_add_u32 v14, v14, v6
    v_add_u32 v15, v15, v14
    v_lshlrev_b32 v16, 8, v4
    v_lshl_add_u32 v16, v3, 2, v16
    v_add_u32 v16, v16, v6
    ds_write_b128 v12, v[140:143]
    ds_write_b64 v14, v[144:145]
    ds_write_b64 v15, v[146:147]
    ds_write_b32 v16, v148 offset:2048
    ds_write_b32 v16, v149 offset:2112
    ds_write_b32 v16, v150 offset:2176
    ds_write_b32 v16, v151 offset:2240
    v_lshlrev_b32 v17, 2, v0
    v_lshlrev_b32 v18, 3, v0
    v_cvt_f32_u32 v40, v18
    s_mov_b32 s12, 4294942400
    v_cmp_gt_u32 vcc, 16, v0
    v_lshlrev_b32 v18, 5, v0
    v_add_f32 v41, 0x3f800000, v40
    v_add_f32 v42, 0x40000000, v40
    v_add_f32 v43, 0x40400000, v40
    v_add_f32 v44, 0x40800000, v40
    v_add_f32 v45, 0x40a00000, v40
    v_add_f32 v46, 0x40c00000, v40
    v_add_f32 v47, 0x40e00000, v40
    v_cvt_pk_bf16_f32 v50, v40, v41
    v_cvt_pk_bf16_f32 v51, v42, v43
    v_cvt_pk_bf16_f32 v52, v44, v45
    v_cvt_pk_bf16_f32 v53, v46, v47
    v_and_b32 v40, 0xffff, v50
    v_lshrrev_b32 v41, 16, v50
    v_and_b32 v42, 0xffff, v51
    v_lshrrev_b32 v43, 16, v51
    v_and_b32 v44, 0xffff, v52
    v_lshrrev_b32 v45, 16, v52
    v_and_b32 v46, 0xffff, v53
    v_lshrrev_b32 v47, 16, v53
    v_lshl_add_u32 v40, v40, 2, s12
    v_add_u32 v54, 43200, v18
    v_cndmask_b32 v40, v40, v54, vcc
    v_lshl_add_u32 v41, v41, 2, s12
    v_add_u32 v54, 43204, v18
    v_cndmask_b32 v41, v41, v54, vcc
    v_lshl_add_u32 v42, v42, 2, s12
    v_add_u32 v54, 43208, v18
    v_cndmask_b32 v42, v42, v54, vcc
    v_lshl_add_u32 v43, v43, 2, s12
    v_add_u32 v54, 43212, v18
    v_cndmask_b32 v43, v43, v54, vcc
    v_lshl_add_u32 v44, v44, 2, s12
    v_add_u32 v54, 43216, v18
    v_cndmask_b32 v44, v44, v54, vcc
    v_lshl_add_u32 v45, v45, 2, s12
    v_add_u32 v54, 43220, v18
    v_cndmask_b32 v45, v45, v54, vcc
    v_lshl_add_u32 v46, v46, 2, s12
    v_add_u32 v54, 43224, v18
    v_cndmask_b32 v46, v46, v54, vcc
    v_lshl_add_u32 v47, v47, 2, s12
    v_add_u32 v54, 43228, v18
    v_cndmask_b32 v47, v47, v54, vcc
    s_add_u32 s56, s52, 1048576
    s_addc_u32 s57, s53, 0
    s_mov_b32 s58, 1835008
    s_mov_b32 s59, 0x00020000
    s_mov_b32 s60, s52
    s_mov_b32 s61, s53
    s_mov_b32 s62, 43520
    s_mov_b32 s63, 0x00020000
    s_add_u32 s68, s52, 7340032
    s_addc_u32 s69, s53, 0
    s_mov_b32 s70, 1835008
    s_mov_b32 s71, 0x00020000
    s_lshl_b32 s5, s4, 6
    v_lshrrev_b32 v5, 2, v0
    v_mul_u32_u24 v5, 28672, v5
    v_and_b32 v6, 3, v0
    v_lshl_add_u32 v5, v6, 4, v5
    v_add_u32 v5, s5, v5
    v_subrev_u32 v6, 1, v0
    v_max_i32 v6, 0, v6
    v_lshrrev_b32 v19, 2, v6
    v_mul_u32_u24 v19, 28672, v19
    v_and_b32 v6, 3, v6
    v_lshl_add_u32 v6, v6, 4, v19
    v_add_u32 v6, s5, v6
    s_lshl_b32 s8, s4, 2
    v_mov_b32 v19, s8
    s_waitcnt lgkmcnt(0)
    s_barrier
    ds_read_b32 v20, v17 offset:0
    ds_read_b32 v21, v17 offset:8704
    ds_read_b32 v22, v17 offset:17408
    ds_read_b32 v23, v17 offset:26112
    ds_read_b32 v24, v17 offset:1024
    ds_read_b32 v25, v17 offset:9728
    ds_read_b32 v26, v17 offset:18432
    ds_read_b32 v27, v17 offset:27136
    ds_read_b32 v28, v17 offset:2048
    ds_read_b32 v29, v17 offset:10752
    ds_read_b32 v30, v17 offset:19456
    ds_read_b32 v31, v17 offset:28160
    s_waitcnt lgkmcnt(0)
    v_add_f32 v20, v20, v21
    v_add_f32 v22, v22, v23
    v_add_f32 v20, v20, v22
    ds_write_b32 v17, v20 offset:43200
    v_add_f32 v24, v24, v25
    v_add_f32 v26, v26, v27
    v_add_f32 v24, v24, v26
    ds_write_b32 v17, v24 offset:44224
    v_add_f32 v28, v28, v29
    v_add_f32 v30, v30, v31
    v_add_f32 v28, v28, v30
    ds_write_b32 v17, v28 offset:45248
    v_and_b32 v16, 31, v1
    v_min_u32 v16, 29, v16
    v_lshlrev_b32 v16, 4, v16
    v_lshrrev_b32 v17, 5, v1
    v_mul_u32_u24 v17, 4576, v17
    v_add_u32 v16, v16, v17
    v_add_u32 v16, 34048, v16
    v_mul_u32_u24 v17, 4256, v1
    v_cmp_gt_u32 vcc, 8, v1
    s_nop 1
    v_cndmask_b32 v17, 16, v17, vcc
    v_and_b32 v18, 1, v2
    v_cmp_eq_u32 vcc, 1, v18
    s_nop 1
    v_cndmask_b32 v16, v16, v17, vcc
    v_mov_b32 v24, 0
    v_mov_b32 v25, 0
    v_mov_b32 v26, 0
    v_mov_b32 v27, 0
    v_lshlrev_b32 v17, 4, v0
    v_mov_b32 v63, s15
    s_waitcnt lgkmcnt(0)
    s_barrier
    ds_read_b32 v80, v40
    ds_read_b32 v81, v41
    ds_read_b32 v82, v42
    ds_read_b32 v83, v43
    ds_read_b32 v84, v44
    ds_read_b32 v85, v45
    ds_read_b32 v86, v46
    ds_read_b32 v87, v47
    ds_write_b128 v16, v[24:27]
    s_waitcnt lgkmcnt(1)
    v_max3_f32 v88, |v80|, |v81|, |v82|
    v_max3_f32 v89, |v83|, |v84|, |v85|
    v_max3_f32 v88, v88, |v86|, |v87|
    v_max_f32 v88, v88, v89
    s_nop 1
    v_max_f32_dpp v89, v88, v88 row_ror:8 row_mask:0xf bank_mask:0xf
    s_nop 1
    v_max_f32_dpp v88, v89, v89 row_ror:4 row_mask:0xf bank_mask:0xf
    s_nop 1
    v_max_f32_dpp v89, v88, v88 row_ror:2 row_mask:0xf bank_mask:0xf
    s_nop 1
    v_max_f32_dpp v88, v89, v89 row_ror:1 row_mask:0xf bank_mask:0xf
    v_mov_b32 v89, v88
    s_nop 1
    v_permlane16_swap_b32 v89, v88
    v_max_f32 v88, v88, v89
    v_mov_b32 v89, v88
    s_nop 1
    v_permlane32_swap_b32 v89, v88
    v_max_f32 v88, v88, v89
    v_lshlrev_b32 v89, 2, v2
    ds_write_b32 v89, v88 offset:46272
    s_waitcnt lgkmcnt(0)
    s_cmp_lg_u32 s7, 0
    s_cbranch_scc1 ka_kernel_polld16
    v_mov_b32 v20, 0
    s_mov_b32 s12, 0x200000
ka_kernel_poll15:
    global_load_dword v21, v20, s[50:51] offset:128 sc1
    s_waitcnt vmcnt(0)
    v_readfirstlane_b32 s10, v21
    s_sub_u32 s12, s12, 1
    s_cmp_eq_u32 s12, 0
    s_nop 2
    s_cbranch_scc1 ka_kernel_polld16
    s_cmp_lg_u32 s10, 0
    s_cbranch_scc1 ka_kernel_polld16
    s_sleep 4
    s_branch ka_kernel_poll15
ka_kernel_polld16:
    s_barrier
    buffer_load_dwordx4 v[100:103], v6, s[56:59], 0 offen sc1
    buffer_load_dwordx4 v[104:107], v5, s[56:59], 0 offen sc1
    buffer_load_dword v108, v19, s[60:63], 0 offen offset:0 sc1
    buffer_load_dword v109, v19, s[60:63], 0 offen offset:3584 sc1
    v_add_u32 v19, 34560, v19
    buffer_load_dword v110, v19, s[60:63], 0 offen sc1
    v_mov_b32 v89, 46272
    ds_read_b128 v[92:95], v89
    s_waitcnt lgkmcnt(0)
    v_max3_f32 v88, v92, v93, v94
    v_max_f32 v88, v88, v95
    v_lshrrev_b32 v89, 23, v88
    v_sub_u32 v89, 267, v89
    v_min_u32 v89, 253, v89
    v_sub_u32 v60, 254, v89
    v_lshlrev_b32 v89, 23, v89
    v_lshlrev_b32 v60, 23, v60
    v_mul_f32 v80, v80, v89
    v_mul_f32 v81, v81, v89
    v_mul_f32 v82, v82, v89
    v_mul_f32 v83, v83, v89
    v_mul_f32 v84, v84, v89
    v_mul_f32 v85, v85, v89
    v_mul_f32 v86, v86, v89
    v_mul_f32 v87, v87, v89
    v_cvt_f16_f32 v80, v80
    v_cvt_f16_f32 v81, v81
    v_cvt_f16_f32 v82, v82
    v_cvt_f16_f32 v83, v83
    v_cvt_f16_f32 v84, v84
    v_cvt_f16_f32 v85, v85
    v_cvt_f16_f32 v86, v86
    v_cvt_f16_f32 v87, v87
    v_pack_b32_f16 v70, v87, v86
    v_pack_b32_f16 v71, v85, v84
    v_pack_b32_f16 v72, v83, v82
    v_pack_b32_f16 v73, v81, v80
    ds_write_b128 v17, v[70:73] offset:34528
    v_cmp_eq_u32 vcc, 0, v0
    s_waitcnt vmcnt(0)
    v_mov_b32 v62, v109
    v_mul_f32 v88, 0x42000000, v110
    v_add_f32 v88, |v88|, |v108|
    v_lshrrev_b32 v89, 23, v88
    v_sub_u32 v89, 268, v89
    v_min_u32 v89, 253, v89
    v_sub_u32 v61, 254, v89
    v_lshlrev_b32 v89, 23, v89
    v_lshlrev_b32 v61, 23, v61
    v_lshlrev_b32 v42, 16, v100
    v_and_b32 v43, 0xffff0000, v100
    v_mul_f32 v42, v42, v110
    v_mul_f32 v43, v43, v110
    v_cvt_pk_bf16_f32 v42, 0, v42
    v_cvt_pk_bf16_f32 v43, 0, v43
    v_add_f32 v42, v42, v108
    v_add_f32 v43, v43, v108
    v_cvt_pk_bf16_f32 v42, 0, v42
    v_cvt_pk_bf16_f32 v43, 0, v43
    v_mul_f32 v42, v42, v89
    v_mul_f32 v43, v43, v89
    v_cvt_pkrtz_f16_f32 v24, v42, v43
    v_cndmask_b32 v24, v24, 0, vcc
    v_lshlrev_b32 v42, 16, v101
    v_and_b32 v43, 0xffff0000, v101
    v_mul_f32 v42, v42, v110
    v_mul_f32 v43, v43, v110
    v_cvt_pk_bf16_f32 v42, 0, v42
    v_cvt_pk_bf16_f32 v43, 0, v43
    v_add_f32 v42, v42, v108
    v_add_f32 v43, v43, v108
    v_cvt_pk_bf16_f32 v42, 0, v42
    v_cvt_pk_bf16_f32 v43, 0, v43
    v_mul_f32 v42, v42, v89
    v_mul_f32 v43, v43, v89
    v_cvt_pkrtz_f16_f32 v25, v42, v43
    v_cndmask_b32 v25, v25, 0, vcc
    v_lshlrev_b32 v42, 16, v102
    v_and_b32 v43, 0xffff0000, v102
    v_mul_f32 v42, v42, v110
    v_mul_f32 v43, v43, v110
    v_cvt_pk_bf16_f32 v42, 0, v42
    v_cvt_pk_bf16_f32 v43, 0, v43
    v_add_f32 v42, v42, v108
    v_add_f32 v43, v43, v108
    v_cvt_pk_bf16_f32 v42, 0, v42
    v_cvt_pk_bf16_f32 v43, 0, v43
    v_mul_f32 v42, v42, v89
    v_mul_f32 v43, v43, v89
    v_cvt_pkrtz_f16_f32 v26, v42, v43
    v_cndmask_b32 v26, v26, 0, vcc
    v_lshlrev_b32 v42, 16, v103
    v_and_b32 v43, 0xffff0000, v103
    v_mul_f32 v42, v42, v110
    v_mul_f32 v43, v43, v110
    v_cvt_pk_bf16_f32 v42, 0, v42
    v_cvt_pk_bf16_f32 v43, 0, v43
    v_add_f32 v42, v42, v108
    v_add_f32 v43, v43, v108
    v_cvt_pk_bf16_f32 v42, 0, v42
    v_cvt_pk_bf16_f32 v43, 0, v43
    v_mul_f32 v42, v42, v89
    v_mul_f32 v43, v43, v89
    v_cvt_pkrtz_f16_f32 v27, v42, v43
    v_cndmask_b32 v27, v27, 0, vcc
    v_lshlrev_b32 v42, 16, v104
    v_and_b32 v43, 0xffff0000, v104
    v_mul_f32 v42, v42, v110
    v_mul_f32 v43, v43, v110
    v_cvt_pk_bf16_f32 v42, 0, v42
    v_cvt_pk_bf16_f32 v43, 0, v43
    v_add_f32 v42, v42, v108
    v_add_f32 v43, v43, v108
    v_cvt_pk_bf16_f32 v42, 0, v42
    v_cvt_pk_bf16_f32 v43, 0, v43
    v_mul_f32 v42, v42, v89
    v_mul_f32 v43, v43, v89
    v_cvt_pkrtz_f16_f32 v28, v42, v43
    v_lshlrev_b32 v42, 16, v105
    v_and_b32 v43, 0xffff0000, v105
    v_mul_f32 v42, v42, v110
    v_mul_f32 v43, v43, v110
    v_cvt_pk_bf16_f32 v42, 0, v42
    v_cvt_pk_bf16_f32 v43, 0, v43
    v_add_f32 v42, v42, v108
    v_add_f32 v43, v43, v108
    v_cvt_pk_bf16_f32 v42, 0, v42
    v_cvt_pk_bf16_f32 v43, 0, v43
    v_mul_f32 v42, v42, v89
    v_mul_f32 v43, v43, v89
    v_cvt_pkrtz_f16_f32 v29, v42, v43
    v_lshlrev_b32 v42, 16, v106
    v_and_b32 v43, 0xffff0000, v106
    v_mul_f32 v42, v42, v110
    v_mul_f32 v43, v43, v110
    v_cvt_pk_bf16_f32 v42, 0, v42
    v_cvt_pk_bf16_f32 v43, 0, v43
    v_add_f32 v42, v42, v108
    v_add_f32 v43, v43, v108
    v_cvt_pk_bf16_f32 v42, 0, v42
    v_cvt_pk_bf16_f32 v43, 0, v43
    v_mul_f32 v42, v42, v89
    v_mul_f32 v43, v43, v89
    v_cvt_pkrtz_f16_f32 v30, v42, v43
    v_lshlrev_b32 v42, 16, v107
    v_and_b32 v43, 0xffff0000, v107
    v_mul_f32 v42, v42, v110
    v_mul_f32 v43, v43, v110
    v_cvt_pk_bf16_f32 v42, 0, v42
    v_cvt_pk_bf16_f32 v43, 0, v43
    v_add_f32 v42, v42, v108
    v_add_f32 v43, v43, v108
    v_cvt_pk_bf16_f32 v42, 0, v42
    v_cvt_pk_bf16_f32 v43, 0, v43
    v_mul_f32 v42, v42, v89
    v_mul_f32 v43, v43, v89
    v_cvt_pkrtz_f16_f32 v31, v42, v43
    v_mov_b32 v34, v25
    v_mov_b32 v35, v26
    v_mov_b32 v36, v27
    v_mov_b32 v37, v28
    v_mov_b32 v38, v29
    v_mov_b32 v39, v30
    v_alignbyte_b32 v46, v25, v24, 2
    v_alignbyte_b32 v47, v26, v25, 2
    v_alignbyte_b32 v48, v27, v26, 2
    v_alignbyte_b32 v49, v28, v27, 2
    v_alignbyte_b32 v50, v29, v28, 2
    v_alignbyte_b32 v51, v30, v29, 2
    v_alignbyte_b32 v52, v31, v30, 2
    v_mov_b32 v54, v47
    v_mov_b32 v55, v48
    v_mov_b32 v56, v49
    v_mov_b32 v57, v50
    v_mov_b32 v58, v51
    v_mov_b32 v59, v52
    ds_write_b128 v17, v[28:31] offset:32
    ds_write_b128 v17, v[46:49] offset:4272
    ds_write_b128 v17, v[34:37] offset:8528
    ds_write_b128 v17, v[54:57] offset:12784
    ds_write_b128 v17, v[26:29] offset:17040
    ds_write_b128 v17, v[48:51] offset:21296
    ds_write_b128 v17, v[36:39] offset:25552
    ds_write_b128 v17, v[56:59] offset:29808
    v_add_u32 v18, 1, v3
    v_and_b32 v19, 7, v18
    v_mul_u32_u24 v19, 4256, v19
    v_lshrrev_b32 v18, 3, v18
    v_sub_u32 v18, v18, v4
    v_add_u32 v18, 3, v18
    v_lshl_add_u32 v19, v18, 4, v19
    v_lshl_add_u32 v19, v2, 7, v19
    v_lshlrev_b32 v18, 5, v3
    v_lshl_add_u32 v18, v4, 4, v18
    v_lshlrev_b32 v20, 7, v2
    v_sub_u32 v18, v18, v20
    v_add_u32 v18, 34432, v18
    v_mov_b32 v64, 0
    v_mov_b32 v65, 0
    v_mov_b32 v66, 0
    v_mov_b32 v67, 0
    v_mov_b32 v68, 0
    v_mov_b32 v69, 0
    v_mov_b32 v70, 0
    v_mov_b32 v71, 0
    v_mov_b32 v72, 0
    v_mov_b32 v73, 0
    v_mov_b32 v74, 0
    v_mov_b32 v75, 0
    v_mov_b32 v76, 0
    v_mov_b32 v77, 0
    v_mov_b32 v78, 0
    v_mov_b32 v79, 0
    v_mov_b32 v80, 0
    v_mov_b32 v81, 0
    v_mov_b32 v82, 0
    v_mov_b32 v83, 0
    v_mov_b32 v84, 0
    v_mov_b32 v85, 0
    v_mov_b32 v86, 0
    v_mov_b32 v87, 0
    v_mov_b32 v88, 0
    v_mov_b32 v89, 0
    v_mov_b32 v90, 0
    v_mov_b32 v91, 0
    v_mov_b32 v92, 0
    v_mov_b32 v93, 0
    v_mov_b32 v94, 0
    v_mov_b32 v95, 0
    s_waitcnt lgkmcnt(0)
    s_barrier
    ds_read_b128 v[96:99], v19 offset:0
    ds_read_b128 v[128:131], v18 offset:64
    ds_read_b128 v[100:103], v19 offset:512
    ds_read_b128 v[132:135], v18 offset:576
    ds_read_b128 v[104:107], v19 offset:1024
    ds_read_b128 v[136:139], v18 offset:1088
    ds_read_b128 v[108:111], v19 offset:1536
    ds_read_b128 v[140:143], v18 offset:1600
    ds_read_b128 v[112:115], v19 offset:2048
    ds_read_b128 v[144:147], v18 offset:2112
    ds_read_b128 v[116:119], v19 offset:2560
    ds_read_b128 v[148:151], v18 offset:2624
    ds_read_b128 v[120:123], v19 offset:3072
    ds_read_b128 v[152:155], v18 offset:3136
    ds_read_b128 v[124:127], v19 offset:3584
    ds_read_b128 v[156:159], v18 offset:3648
    s_waitcnt lgkmcnt(14)
    v_mfma_f32_16x16x32_f16 v[64:67], v[96:99], v[128:131], v[64:67]
    s_waitcnt lgkmcnt(12)
    v_mfma_f32_16x16x32_f16 v[68:71], v[96:99], v[132:135], v[68:71]
    v_mfma_f32_16x16x32_f16 v[68:71], v[100:103], v[128:131], v[68:71]
    v_mfma_f32_16x16x32_f16 v[72:75], v[100:103], v[132:135], v[72:75]
    s_waitcnt lgkmcnt(10)
    v_mfma_f32_16x16x32_f16 v[72:75], v[96:99], v[136:139], v[72:75]
    v_mfma_f32_16x16x32_f16 v[76:79], v[100:103], v[136:139], v[76:79]
    v_mfma_f32_16x16x32_f16 v[72:75], v[104:107], v[128:131], v[72:75]
    v_mfma_f32_16x16x32_f16 v[76:79], v[104:107], v[132:135], v[76:79]
    v_mfma_f32_16x16x32_f16 v[80:83], v[104:107], v[136:139], v[80:83]
    s_waitcnt lgkmcnt(8)
    v_mfma_f32_16x16x32_f16 v[76:79], v[96:99], v[140:143], v[76:79]
    v_mfma_f32_16x16x32_f16 v[80:83], v[100:103], v[140:143], v[80:83]
    v_mfma_f32_16x16x32_f16 v[84:87], v[104:107], v[140:143], v[84:87]
    v_mfma_f32_16x16x32_f16 v[76:79], v[108:111], v[128:131], v[76:79]
    v_mfma_f32_16x16x32_f16 v[80:83], v[108:111], v[132:135], v[80:83]
    v_mfma_f32_16x16x32_f16 v[84:87], v[108:111], v[136:139], v[84:87]
    v_mfma_f32_16x16x32_f16 v[88:91], v[108:111], v[140:143], v[88:91]
    s_waitcnt lgkmcnt(6)
    v_mfma_f32_16x16x32_f16 v[80:83], v[96:99], v[144:147], v[80:83]
    v_mfma_f32_16x16x32_f16 v[84:87], v[100:103], v[144:147], v[84:87]
    v_mfma_f32_16x16x32_f16 v[88:91], v[104:107], v[144:147], v[88:91]
    v_mfma_f32_16x16x32_f16 v[92:95], v[108:111], v[144:147], v[92:95]
    v_mfma_f32_16x16x32_f16 v[80:83], v[112:115], v[128:131], v[80:83]
    v_mfma_f32_16x16x32_f16 v[84:87], v[112:115], v[132:135], v[84:87]
    v_mfma_f32_16x16x32_f16 v[88:91], v[112:115], v[136:139], v[88:91]
    v_mfma_f32_16x16x32_f16 v[92:95], v[112:115], v[140:143], v[92:95]
    s_waitcnt lgkmcnt(4)
    v_mfma_f32_16x16x32_f16 v[84:87], v[96:99], v[148:151], v[84:87]
    v_mfma_f32_16x16x32_f16 v[88:91], v[100:103], v[148:151], v[88:91]
    v_mfma_f32_16x16x32_f16 v[92:95], v[104:107], v[148:151], v[92:95]
    v_mfma_f32_16x16x32_f16 v[84:87], v[116:119], v[128:131], v[84:87]
    v_mfma_f32_16x16x32_f16 v[88:91], v[116:119], v[132:135], v[88:91]
    v_mfma_f32_16x16x32_f16 v[92:95], v[116:119], v[136:139], v[92:95]
    s_waitcnt lgkmcnt(2)
    v_mfma_f32_16x16x32_f16 v[88:91], v[96:99], v[152:155], v[88:91]
    v_mfma_f32_16x16x32_f16 v[92:95], v[100:103], v[152:155], v[92:95]
    v_mfma_f32_16x16x32_f16 v[88:91], v[120:123], v[128:131], v[88:91]
    v_mfma_f32_16x16x32_f16 v[92:95], v[120:123], v[132:135], v[92:95]
    s_waitcnt lgkmcnt(0)
    v_mfma_f32_16x16x32_f16 v[92:95], v[96:99], v[156:159], v[92:95]
    v_mfma_f32_16x16x32_f16 v[92:95], v[124:127], v[128:131], v[92:95]
    ds_read_b128 v[96:99], v19 offset:64
    ds_read_b128 v[128:131], v18 offset:0
    ds_read_b128 v[100:103], v19 offset:576
    ds_read_b128 v[132:135], v18 offset:512
    ds_read_b128 v[104:107], v19 offset:1088
    ds_read_b128 v[136:139], v18 offset:1024
    ds_read_b128 v[108:111], v19 offset:1600
    ds_read_b128 v[140:143], v18 offset:1536
    ds_read_b128 v[112:115], v19 offset:2112
    ds_read_b128 v[144:147], v18 offset:2048
    ds_read_b128 v[116:119], v19 offset:2624
    ds_read_b128 v[148:151], v18 offset:2560
    ds_read_b128 v[120:123], v19 offset:3136
    ds_read_b128 v[152:155], v18 offset:3072
    ds_read_b128 v[124:127], v19 offset:3648
    ds_read_b128 v[156:159], v18 offset:3584
    s_waitcnt lgkmcnt(14)
    v_mfma_f32_16x16x32_f16 v[64:67], v[96:99], v[128:131], v[64:67]
    s_waitcnt lgkmcnt(12)
    v_mfma_f32_16x16x32_f16 v[68:71], v[96:99], v[132:135], v[68:71]
    v_mfma_f32_16x16x32_f16 v[68:71], v[100:103], v[128:131], v[68:71]
    v_mfma_f32_16x16x32_f16 v[72:75], v[100:103], v[132:135], v[72:75]
    s_waitcnt lgkmcnt(10)
    v_mfma_f32_16x16x32_f16 v[72:75], v[96:99], v[136:139], v[72:75]
    v_mfma_f32_16x16x32_f16 v[76:79], v[100:103], v[136:139], v[76:79]
    v_mfma_f32_16x16x32_f16 v[72:75], v[104:107], v[128:131], v[72:75]
    v_mfma_f32_16x16x32_f16 v[76:79], v[104:107], v[132:135], v[76:79]
    v_mfma_f32_16x16x32_f16 v[80:83], v[104:107], v[136:139], v[80:83]
    s_waitcnt lgkmcnt(8)
    v_mfma_f32_16x16x32_f16 v[76:79], v[96:99], v[140:143], v[76:79]
    v_mfma_f32_16x16x32_f16 v[80:83], v[100:103], v[140:143], v[80:83]
    v_mfma_f32_16x16x32_f16 v[84:87], v[104:107], v[140:143], v[84:87]
    v_mfma_f32_16x16x32_f16 v[76:79], v[108:111], v[128:131], v[76:79]
    v_mfma_f32_16x16x32_f16 v[80:83], v[108:111], v[132:135], v[80:83]
    v_mfma_f32_16x16x32_f16 v[84:87], v[108:111], v[136:139], v[84:87]
    v_mfma_f32_16x16x32_f16 v[88:91], v[108:111], v[140:143], v[88:91]
    s_waitcnt lgkmcnt(6)
    v_mfma_f32_16x16x32_f16 v[80:83], v[96:99], v[144:147], v[80:83]
    v_mfma_f32_16x16x32_f16 v[84:87], v[100:103], v[144:147], v[84:87]
    v_mfma_f32_16x16x32_f16 v[88:91], v[104:107], v[144:147], v[88:91]
    v_mfma_f32_16x16x32_f16 v[92:95], v[108:111], v[144:147], v[92:95]
    v_mfma_f32_16x16x32_f16 v[80:83], v[112:115], v[128:131], v[80:83]
    v_mfma_f32_16x16x32_f16 v[84:87], v[112:115], v[132:135], v[84:87]
    v_mfma_f32_16x16x32_f16 v[88:91], v[112:115], v[136:139], v[88:91]
    v_mfma_f32_16x16x32_f16 v[92:95], v[112:115], v[140:143], v[92:95]
    s_waitcnt lgkmcnt(4)
    v_mfma_f32_16x16x32_f16 v[84:87], v[96:99], v[148:151], v[84:87]
    v_mfma_f32_16x16x32_f16 v[88:91], v[100:103], v[148:151], v[88:91]
    v_mfma_f32_16x16x32_f16 v[92:95], v[104:107], v[148:151], v[92:95]
    v_mfma_f32_16x16x32_f16 v[84:87], v[116:119], v[128:131], v[84:87]
    v_mfma_f32_16x16x32_f16 v[88:91], v[116:119], v[132:135], v[88:91]
    v_mfma_f32_16x16x32_f16 v[92:95], v[116:119], v[136:139], v[92:95]
    s_waitcnt lgkmcnt(2)
    v_mfma_f32_16x16x32_f16 v[88:91], v[96:99], v[152:155], v[88:91]
    v_mfma_f32_16x16x32_f16 v[92:95], v[100:103], v[152:155], v[92:95]
    v_mfma_f32_16x16x32_f16 v[88:91], v[120:123], v[128:131], v[88:91]
    v_mfma_f32_16x16x32_f16 v[92:95], v[120:123], v[132:135], v[92:95]
    s_waitcnt lgkmcnt(0)
    v_mfma_f32_16x16x32_f16 v[92:95], v[96:99], v[156:159], v[92:95]
    v_mfma_f32_16x16x32_f16 v[92:95], v[124:127], v[128:131], v[92:95]
    v_lshlrev_b32 v20, 4, v1
    v_lshl_add_u32 v21, v2, 13, v20
    v_lshl_add_u32 v20, v2, 11, v20
    v_add_u32 v20, 4256, v20
    v_add_u32 v21, 4256, v21
    s_barrier
    ds_write_b128 v21, v[64:67] offset:0
    ds_write_b128 v21, v[68:71] offset:1024
    ds_write_b128 v21, v[72:75] offset:2048
    ds_write_b128 v21, v[76:79] offset:3072
    ds_write_b128 v21, v[80:83] offset:4096
    ds_write_b128 v21, v[84:87] offset:5120
    ds_write_b128 v21, v[88:91] offset:6144
    ds_write_b128 v21, v[92:95] offset:7168
    v_lshlrev_b32 v22, 5, v3
    v_lshl_add_u32 v22, v4, 3, v22
    v_lshl_add_u32 v22, v2, 10, v22
    v_lshrrev_b32 v23, 2, v3
    v_lshl_add_u32 v23, v2, 3, v23
    v_mul_u32_u24 v23, 57344, v23
    v_and_b32 v24, 3, v3
    v_lshl_add_u32 v23, v24, 5, v23
    v_lshl_add_u32 v23, v4, 3, v23
    s_lshl_b32 s16, s4, 7
    s_add_u32 s17, s16, 229376
    s_waitcnt lgkmcnt(0)
    s_barrier
    ds_read_b128 v[96:99], v20 offset:0
    ds_read_b128 v[100:103], v20 offset:8192
    ds_read_b128 v[104:107], v20 offset:16384
    ds_read_b128 v[108:111], v20 offset:24576
    ds_read_b64 v[128:129], v22 offset:32
    ds_read_b128 v[112:115], v20 offset:1024
    ds_read_b128 v[116:119], v20 offset:9216
    ds_read_b128 v[120:123], v20 offset:17408
    ds_read_b128 v[124:127], v20 offset:25600
    ds_read_b64 v[130:131], v22 offset:544
    s_waitcnt lgkmcnt(5)
    v_add_f32 v96, v96, v100
    v_add_f32 v104, v104, v108
    v_add_f32 v96, v96, v104
    v_add_f32 v97, v97, v101
    v_add_f32 v105, v105, v109
    v_add_f32 v97, v97, v105
    v_add_f32 v98, v98, v102
    v_add_f32 v106, v106, v110
    v_add_f32 v98, v98, v106
    v_add_f32 v99, v99, v103
    v_add_f32 v107, v107, v111
    v_add_f32 v99, v99, v107
    v_mul_f32 v96, v96, v60
    v_mul_f32 v97, v97, v60
    v_mul_f32 v98, v98, v60
    v_mul_f32 v99, v99, v60
    v_mul_f32 v96, v96, v61
    v_mul_f32 v97, v97, v61
    v_mul_f32 v98, v98, v61
    v_mul_f32 v99, v99, v61
    v_cvt_f32_f16 v100, v128
    v_lshrrev_b32 v101, 16, v128
    v_cvt_f32_f16 v101, v101
    v_cvt_f32_f16 v102, v129
    v_lshrrev_b32 v103, 16, v129
    v_cvt_f32_f16 v103, v103
    v_mul_f32 v100, v100, v61
    v_mul_f32 v101, v101, v61
    v_mul_f32 v102, v102, v61
    v_mul_f32 v103, v103, v61
    v_cvt_pk_bf16_f32 v96, 0, v96
    v_cvt_pk_bf16_f32 v97, 0, v97
    v_cvt_pk_bf16_f32 v98, 0, v98
    v_cvt_pk_bf16_f32 v99, 0, v99
    v_mul_f32 v100, v100, v63
    v_mul_f32 v101, v101, v63
    v_mul_f32 v102, v102, v63
    v_mul_f32 v103, v103, v63
    v_cvt_pk_bf16_f32 v100, 0, v100
    v_cvt_pk_bf16_f32 v101, 0, v101
    v_cvt_pk_bf16_f32 v102, 0, v102
    v_cvt_pk_bf16_f32 v103, 0, v103
    v_add_f32 v96, v96, v100
    v_add_f32 v97, v97, v101
    v_add_f32 v98, v98, v102
    v_add_f32 v99, v99, v103
    v_cvt_pk_bf16_f32 v96, 0, v96
    v_cvt_pk_bf16_f32 v97, 0, v97
    v_cvt_pk_bf16_f32 v98, 0, v98
    v_cvt_pk_bf16_f32 v99, 0, v99
    v_mul_f32 v96, v96, v62
    v_mul_f32 v97, v97, v62
    v_mul_f32 v98, v98, v62
    v_mul_f32 v99, v99, v62
    v_cvt_pk_bf16_f32 v104, v96, v97
    v_cvt_pk_bf16_f32 v105, v98, v99
    buffer_store_dwordx2 v[104:105], v23, s[68:71], s16 offen
    s_waitcnt lgkmcnt(0)
    v_add_f32 v112, v112, v116
    v_add_f32 v120, v120, v124
    v_add_f32 v112, v112, v120
    v_add_f32 v113, v113, v117
    v_add_f32 v121, v121, v125
    v_add_f32 v113, v113, v121
    v_add_f32 v114, v114, v118
    v_add_f32 v122, v122, v126
    v_add_f32 v114, v114, v122
    v_add_f32 v115, v115, v119
    v_add_f32 v123, v123, v127
    v_add_f32 v115, v115, v123
    v_mul_f32 v112, v112, v60
    v_mul_f32 v113, v113, v60
    v_mul_f32 v114, v114, v60
    v_mul_f32 v115, v115, v60
    v_mul_f32 v112, v112, v61
    v_mul_f32 v113, v113, v61
    v_mul_f32 v114, v114, v61
    v_mul_f32 v115, v115, v61
    v_cvt_f32_f16 v116, v130
    v_lshrrev_b32 v117, 16, v130
    v_cvt_f32_f16 v117, v117
    v_cvt_f32_f16 v118, v131
    v_lshrrev_b32 v119, 16, v131
    v_cvt_f32_f16 v119, v119
    v_mul_f32 v116, v116, v61
    v_mul_f32 v117, v117, v61
    v_mul_f32 v118, v118, v61
    v_mul_f32 v119, v119, v61
    v_cvt_pk_bf16_f32 v112, 0, v112
    v_cvt_pk_bf16_f32 v113, 0, v113
    v_cvt_pk_bf16_f32 v114, 0, v114
    v_cvt_pk_bf16_f32 v115, 0, v115
    v_mul_f32 v116, v116, v63
    v_mul_f32 v117, v117, v63
    v_mul_f32 v118, v118, v63
    v_mul_f32 v119, v119, v63
    v_cvt_pk_bf16_f32 v116, 0, v116
    v_cvt_pk_bf16_f32 v117, 0, v117
    v_cvt_pk_bf16_f32 v118, 0, v118
    v_cvt_pk_bf16_f32 v119, 0, v119
    v_add_f32 v112, v112, v116
    v_add_f32 v113, v113, v117
    v_add_f32 v114, v114, v118
    v_add_f32 v115, v115, v119
    v_cvt_pk_bf16_f32 v112, 0, v112
    v_cvt_pk_bf16_f32 v113, 0, v113
    v_cvt_pk_bf16_f32 v114, 0, v114
    v_cvt_pk_bf16_f32 v115, 0, v115
    v_mul_f32 v112, v112, v62
    v_mul_f32 v113, v113, v62
    v_mul_f32 v114, v114, v62
    v_mul_f32 v115, v115, v62
    v_cvt_pk_bf16_f32 v120, v112, v113
    v_cvt_pk_bf16_f32 v121, v114, v115
    buffer_store_dwordx2 v[120:121], v23, s[68:71], s17 offen
    s_endpgm
ka_end:
    s_endpgm

.globl kb_kernel
.p2align 8
.type kb_kernel,@function
kb_kernel:
    s_cmp_ge_u32 s2, 256
    s_cbranch_scc1 kb_end
    s_load_dwordx2 s[52:53], s[0:1], 144
    s_load_dwordx2 s[16:17], s[0:1], 0
    s_load_dwordx2 s[48:49], s[0:1], 128
    v_and_b32 v1, 63, v0
    v_lshrrev_b32 v2, 6, v0
    v_and_b32 v3, 15, v0
    v_bfe_u32 v4, v0, 4, 2
    v_readfirstlane_b32 s7, v2
    s_and_b32 s4, s2, 7
    s_lshr_b32 s5, s2, 3
    s_lshl_b32 s4, s4, 4
    s_lshr_b32 s6, s5, 1
    s_add_u32 s4, s4, s6
    s_and_b32 s5, s5, 1
    s_lshl_b32 s99, s4, 7
    s_add_u32 s99, s99, 262144
    s_mul_i32 s8, s4, 14336
    s_lshl_b32 s4, s4, 4
    s_mul_i32 s9, s5, 448
    s_mul_i32 s13, s5, 200704
    v_lshlrev_b32 v6, 4, v0
    v_lshrrev_b32 v5, 5, v0
    v_and_b32 v9, 31, v0
    v_mul_u32_u24 v8, 896, v5
    v_lshl_add_u32 v8, v9, 2, v8
    v_lshlrev_b32 v7, 3, v9
    s_lshl_b32 s11, s7, 10
    v_lshrrev_b32 v10, 1, v0
    v_lshlrev_b32 v10, 7, v10
    v_and_b32 v11, 1, v0
    v_lshl_add_u32 v10, v11, 4, v10
    v_mov_b32 v48, 0x7ff00000
    v_add_u32 v11, 32768, v10
    v_cmp_lt_u32 vcc, 5, v2
    s_nop 1
    v_cndmask_b32 v11, v11, v48, vcc
    s_lshr_b32 s12, s4, 6
    s_mul_i32 s12, s12, 57344
    s_and_b32 s14, s4, 63
    s_lshl_b32 s14, s14, 1
    s_add_u32 s12, s12, s14
    s_waitcnt lgkmcnt(0)
    s_mov_b32 s92, s52
    s_mov_b32 s93, s53
    s_mov_b32 s94, 1048576
    s_mov_b32 s95, 0x00020000
    s_add_u32 s56, s52, 7340032
    s_addc_u32 s57, s53, 0
    s_mov_b32 s58, 1835008
    s_mov_b32 s59, 0x00020000
    s_mov_b32 s60, s16
    s_mov_b32 s61, s17
    s_mov_b32 s62, 1835008
    s_mov_b32 s63, 0x00020000
    s_add_u32 s64, s52, 26214400
    s_addc_u32 s65, s53, 0
    s_mov_b32 s66, 401408
    s_mov_b32 s67, 0x00020000
    s_mov_b32 s68, s52
    s_mov_b32 s69, s53
    s_mov_b32 s70, 43520
    s_mov_b32 s71, 0x00020000
    s_add_u32 m0, s11, 0
    s_nop 0
    buffer_load_dwordx4 v10, s[56:59], s12 offen lds
    s_add_u32 m0, s11, 8192
    s_nop 0
    buffer_load_dwordx4 v11, s[56:59], s12 offen lds
    s_cmp_lg_u32 s7, 0
    s_cbranch_scc1 kb_kernel_tk1
    s_getreg_b32 s21, hwreg(HW_REG_XCC_ID, 0, 4)
    s_and_b32 s21, s21, 7
    s_lshl_b32 s22, s21, 7
    s_add_u32 s22, s22, 282624
    v_mov_b32 v248, 1
    v_mov_b32 v249, 0
    s_mov_b64 s[96:97], exec
    s_mov_b64 exec, 1
    buffer_atomic_add v248, v249, s[92:95], s22 offen sc0 sc1
    s_mov_b64 exec, s[96:97]
kb_kernel_tk1:
    buffer_load_dword v12, v8, s[60:63], s8 offen offset:0
    buffer_load_dword v13, v8, s[60:63], s8 offen offset:128
    buffer_load_dword v14, v8, s[60:63], s8 offen offset:256
    buffer_load_dword v15, v8, s[60:63], s8 offen offset:384
    buffer_load_dword v16, v8, s[60:63], s8 offen offset:512
    buffer_load_dword v17, v8, s[60:63], s8 offen offset:640
    buffer_load_dword v18, v8, s[60:63], s8 offen offset:768
    s_mov_b32 s11, 39936
    s_mov_b32 s12, 5376
    buffer_load_dwordx2 v[20:21], v7, s[68:71], s11 offen offset:0
    buffer_load_dwordx2 v[34:35], v7, s[68:71], s12 offen offset:0
    buffer_load_dwordx2 v[22:23], v7, s[68:71], s11 offen offset:256
    buffer_load_dwordx2 v[36:37], v7, s[68:71], s12 offen offset:256
    buffer_load_dwordx2 v[24:25], v7, s[68:71], s11 offen offset:512
    buffer_load_dwordx2 v[38:39], v7, s[68:71], s12 offen offset:512
    buffer_load_dwordx2 v[26:27], v7, s[68:71], s11 offen offset:768
    buffer_load_dwordx2 v[40:41], v7, s[68:71], s12 offen offset:768
    buffer_load_dwordx2 v[28:29], v7, s[68:71], s11 offen offset:1024
    buffer_load_dwordx2 v[42:43], v7, s[68:71], s12 offen offset:1024
    buffer_load_dwordx2 v[30:31], v7, s[68:71], s11 offen offset:1280
    buffer_load_dwordx2 v[44:45], v7, s[68:71], s12 offen offset:1280
    buffer_load_dwordx2 v[32:33], v7, s[68:71], s11 offen offset:1536
    buffer_load_dwordx2 v[46:47], v7, s[68:71], s12 offen offset:1536
    s_add_u32 s14, s13, 100352
    v_lshl_add_u32 v48, v2, 2, v4
    v_lshrrev_b32 v49, 2, v3
    v_lshl_add_u32 v49, v48, 2, v49
    v_lshlrev_b32 v49, 5, v49
    v_and_b32 v50, 3, v3
    v_lshl_add_u32 v49, v50, 3, v49
    v_mul_u32_u24 v50, 904, v3
    v_lshl_add_u32 v50, v48, 3, v50
    v_add_u32 v50, 16384, v50
    v_mul_u32_u24 v51, 904, v5
    v_lshl_add_u32 v51, v9, 2, v51
    v_add_u32 v51, 16384, v51
    v_lshrrev_b32 v52, 1, v5
    v_lshrrev_b32 v53, 2, v9
    v_xor_b32 v52, v52, v53
    v_lshlrev_b32 v52, 4, v52
    v_lshl_add_u32 v52, v5, 7, v52
    v_and_b32 v53, 3, v9
    v_lshl_add_u32 v52, v53, 2, v52
    s_waitcnt vmcnt(21)
    s_barrier
    ds_read_b64_tr_b16 v[54:55], v49 offset:0
    ds_read_b64_tr_b16 v[56:57], v49 offset:4096
    ds_read_b64_tr_b16 v[58:59], v49 offset:8192
    s_cmp_gt_u32 s7, 3
    s_cbranch_scc1 kb_kernel_r32
    ds_read_b64_tr_b16 v[60:61], v49 offset:12288
    s_waitcnt lgkmcnt(0)
    ds_write_b64 v50, v[60:61] offset:768
kb_kernel_r32:
    s_waitcnt lgkmcnt(0)
    ds_write_b64 v50, v[54:55] offset:0
    ds_write_b64 v50, v[56:57] offset:256
    ds_write_b64 v50, v[58:59] offset:512
    s_waitcnt lgkmcnt(0)
    s_barrier
    ds_read_b32 v54, v51 offset:0
    ds_read_b32 v55, v51 offset:128
    ds_read_b32 v56, v51 offset:256
    ds_read_b32 v57, v51 offset:384
    ds_read_b32 v58, v51 offset:512
    ds_read_b32 v59, v51 offset:640
    ds_read_b32 v60, v51 offset:768
    s_cmp_eq_u32 s5, 1
    s_cselect_b32 s15, 2097152, 0
    s_add_u32 s15, s15, s8
    s_add_u32 s76, s52, 9437184
    s_addc_u32 s77, s53, 0
    s_mov_b32 s78, 3932160
    s_mov_b32 s79, 0x00020000
    s_waitcnt vmcnt(0)
    s_waitcnt lgkmcnt(0)
    buffer_load_dwordx4 v[100:103], v6, s[64:67], s13 offen
    buffer_load_dwordx4 v[104:107], v6, s[64:67], s14 offen
    s_add_u32 s13, s13, 7168
    s_add_u32 s14, s14, 7168
    v_lshlrev_b32 v62, 16, v12
    v_and_b32 v63, 0xffff0000, v12
    v_lshlrev_b32 v76, 16, v54
    v_and_b32 v77, 0xffff0000, v54
    v_add_f32 v62, v62, v76
    v_add_f32 v63, v63, v77
    v_cvt_pk_bf16_f32 v84, v62, v63
    v_lshlrev_b32 v64, 16, v13
    v_and_b32 v65, 0xffff0000, v13
    v_lshlrev_b32 v76, 16, v55
    v_and_b32 v77, 0xffff0000, v55
    v_add_f32 v64, v64, v76
    v_add_f32 v65, v65, v77
    v_cvt_pk_bf16_f32 v85, v64, v65
    v_lshlrev_b32 v66, 16, v14
    v_and_b32 v67, 0xffff0000, v14
    v_lshlrev_b32 v76, 16, v56
    v_and_b32 v77, 0xffff0000, v56
    v_add_f32 v66, v66, v76
    v_add_f32 v67, v67, v77
    v_cvt_pk_bf16_f32 v86, v66, v67
    v_lshlrev_b32 v68, 16, v15
    v_and_b32 v69, 0xffff0000, v15
    v_lshlrev_b32 v76, 16, v57
    v_and_b32 v77, 0xffff0000, v57
    v_add_f32 v68, v68, v76
    buffer_load_dwordx4 v[108:111], v6, s[64:67], s13 offen
    buffer_load_dwordx4 v[112:115], v6, s[64:67], s14 offen
    s_add_u32 s13, s13, 7168
    s_add_u32 s14, s14, 7168
    v_add_f32 v69, v69, v77
    v_cvt_pk_bf16_f32 v87, v68, v69
    v_lshlrev_b32 v70, 16, v16
    v_and_b32 v71, 0xffff0000, v16
    v_lshlrev_b32 v76, 16, v58
    v_and_b32 v77, 0xffff0000, v58
    v_add_f32 v70, v70, v76
    v_add_f32 v71, v71, v77
    v_cvt_pk_bf16_f32 v88, v70, v71
    v_lshlrev_b32 v72, 16, v17
    v_and_b32 v73, 0xffff0000, v17
    v_lshlrev_b32 v76, 16, v59
    v_and_b32 v77, 0xffff0000, v59
    v_add_f32 v72, v72, v76
    v_add_f32 v73, v73, v77
    v_cvt_pk_bf16_f32 v89, v72, v73
    v_lshlrev_b32 v74, 16, v18
    v_and_b32 v75, 0xffff0000, v18
    v_lshlrev_b32 v76, 16, v60
    v_and_b32 v77, 0xffff0000, v60
    v_add_f32 v74, v74, v76
    v_add_f32 v75, v75, v77
    v_cvt_pk_bf16_f32 v90, v74, v75
    v_cvt_pk_bf16_f32 v62, 0, v62
    v_cvt_pk_bf16_f32 v63, 0, v63
    v_cvt_pk_bf16_f32 v64, 0, v64
    v_cvt_pk_bf16_f32 v65, 0, v65
    buffer_load_dwordx4 v[116:119], v6, s[64:67], s13 offen
    buffer_load_dwordx4 v[120:123], v6, s[64:67], s14 offen
    s_add_u32 s13, s13, 7168
    s_add_u32 s14, s14, 7168
    v_cvt_pk_bf16_f32 v66, 0, v66
    v_cvt_pk_bf16_f32 v67, 0, v67
    v_cvt_pk_bf16_f32 v68, 0, v68
    v_cvt_pk_bf16_f32 v69, 0, v69
    v_cvt_pk_bf16_f32 v70, 0, v70
    v_cvt_pk_bf16_f32 v71, 0, v71
    v_cvt_pk_bf16_f32 v72, 0, v72
    v_cvt_pk_bf16_f32 v73, 0, v73
    v_cvt_pk_bf16_f32 v74, 0, v74
    v_cvt_pk_bf16_f32 v75, 0, v75
    v_add_f32 v76, v62, v66
    v_add_f32 v77, v63, v67
    v_add_f32 v78, v64, v68
    v_add_f32 v79, v65, v69
    v_add_f32 v76, v76, v70
    v_add_f32 v77, v77, v71
    v_add_f32 v78, v78, v72
    v_add_f32 v79, v79, v73
    v_add_f32 v76, v76, v74
    v_add_f32 v77, v77, v75
    v_add_f32 v76, v76, v77
    v_add_f32 v78, v78, v79
    v_add_f32 v81, v76, v78
    s_nop 1
    v_add_f32_dpp v80, v81, v81 row_ror:8 row_mask:0xf bank_mask:0xf
    s_nop 1
    v_add_f32_dpp v81, v80, v80 row_ror:4 row_mask:0xf bank_mask:0xf
    s_nop 1
    v_add_f32_dpp v80, v81, v81 row_ror:2 row_mask:0xf bank_mask:0xf
    buffer_load_dwordx4 v[124:127], v6, s[64:67], s13 offen
    buffer_load_dwordx4 v[128:131], v6, s[64:67], s14 offen
    s_add_u32 s13, s13, 7168
    s_add_u32 s14, s14, 7168
    v_add_f32_dpp v81, v80, v80 row_ror:1 row_mask:0xf bank_mask:0xf
    v_mov_b32 v80, v81
    s_nop 1
    v_permlane16_swap_b32 v80, v81
    v_add_f32 v81, v81, v80
    v_mul_f32 v81, 0x3b124925, v81
    v_sub_f32 v80, v62, v81
    v_mul_f32 v76, v80, v80
    v_sub_f32 v82, v63, v81
    v_mul_f32 v77, v82, v82
    v_sub_f32 v80, v64, v81
    v_mul_f32 v78, v80, v80
    v_sub_f32 v82, v65, v81
    v_mul_f32 v79, v82, v82
    v_sub_f32 v80, v66, v81
    v_fmac_f32 v76, v80, v80
    v_sub_f32 v82, v67, v81
    v_fmac_f32 v77, v82, v82
    v_sub_f32 v80, v68, v81
    v_fmac_f32 v78, v80, v80
    v_sub_f32 v82, v69, v81
    v_fmac_f32 v79, v82, v82
    v_sub_f32 v80, v70, v81
    v_fmac_f32 v76, v80, v80
    v_sub_f32 v82, v71, v81
    v_fmac_f32 v77, v82, v82
    v_sub_f32 v80, v72, v81
    v_fmac_f32 v78, v80, v80
    buffer_load_dwordx4 v[132:135], v6, s[64:67], s13 offen
    buffer_load_dwordx4 v[136:139], v6, s[64:67], s14 offen
    s_add_u32 s13, s13, 7168
    s_add_u32 s14, s14, 7168
    v_sub_f32 v82, v73, v81
    v_fmac_f32 v79, v82, v82
    v_sub_f32 v80, v74, v81
    v_fmac_f32 v76, v80, v80
    v_sub_f32 v82, v75, v81
    v_fmac_f32 v77, v82, v82
    v_add_f32 v76, v76, v77
    v_add_f32 v78, v78, v79
    v_add_f32 v83, v76, v78
    s_nop 1
    v_add_f32_dpp v80, v83, v83 row_ror:8 row_mask:0xf bank_mask:0xf
    s_nop 1
    v_add_f32_dpp v83, v80, v80 row_ror:4 row_mask:0xf bank_mask:0xf
    s_nop 1
    v_add_f32_dpp v80, v83, v83 row_ror:2 row_mask:0xf bank_mask:0xf
    s_nop 1
    v_add_f32_dpp v83, v80, v80 row_ror:1 row_mask:0xf bank_mask:0xf
    v_mov_b32 v80, v83
    s_nop 1
    v_permlane16_swap_b32 v80, v83
    v_add_f32 v83, v83, v80
    v_mul_f32 v83, 0x3b124925, v83
    v_cvt_pk_bf16_f32 v83, 0, v83
    v_add_f32 v83, 0x3727c5ac, v83
    v_cvt_pk_bf16_f32 v83, 0, v83
    v_sqrt_f32 v83, v83
    s_nop 0
    v_cvt_pk_bf16_f32 v83, 0, v83
    v_rcp_f32 v83, v83
    v_cvt_pk_bf16_f32 v82, 0, v81
    v_sub_f32 v62, v62, v82
    v_sub_f32 v63, v63, v82
    buffer_load_dwordx4 v[140:143], v6, s[64:67], s13 offen
    buffer_load_dwordx4 v[144:147], v6, s[64:67], s14 offen
    s_add_u32 s13, s13, 7168
    s_add_u32 s14, s14, 7168
    v_sub_f32 v64, v64, v82
    v_sub_f32 v65, v65, v82
    v_sub_f32 v66, v66, v82
    v_sub_f32 v67, v67, v82
    v_sub_f32 v68, v68, v82
    v_sub_f32 v69, v69, v82
    v_sub_f32 v70, v70, v82
    v_sub_f32 v71, v71, v82
    v_sub_f32 v72, v72, v82
    v_sub_f32 v73, v73, v82
    v_sub_f32 v74, v74, v82
    v_sub_f32 v75, v75, v82
    v_cvt_pk_bf16_f32 v62, 0, v62
    v_cvt_pk_bf16_f32 v63, 0, v63
    v_cvt_pk_bf16_f32 v64, 0, v64
    v_cvt_pk_bf16_f32 v65, 0, v65
    v_cvt_pk_bf16_f32 v66, 0, v66
    v_cvt_pk_bf16_f32 v67, 0, v67
    v_cvt_pk_bf16_f32 v68, 0, v68
    v_cvt_pk_bf16_f32 v69, 0, v69
    v_cvt_pk_bf16_f32 v70, 0, v70
    v_cvt_pk_bf16_f32 v71, 0, v71
    v_cvt_pk_bf16_f32 v72, 0, v72
    v_cvt_pk_bf16_f32 v73, 0, v73
    v_cvt_pk_bf16_f32 v74, 0, v74
    v_cvt_pk_bf16_f32 v75, 0, v75
    v_mul_f32 v62, v62, v83
    buffer_load_dwordx4 v[148:151], v6, s[64:67], s13 offen
    buffer_load_dwordx4 v[152:155], v6, s[64:67], s14 offen
    s_add_u32 s13, s13, 7168
    s_add_u32 s14, s14, 7168
    v_mul_f32 v63, v63, v83
    v_mul_f32 v64, v64, v83
    v_mul_f32 v65, v65, v83
    v_mul_f32 v66, v66, v83
    v_mul_f32 v67, v67, v83
    v_mul_f32 v68, v68, v83
    v_mul_f32 v69, v69, v83
    v_mul_f32 v70, v70, v83
    v_mul_f32 v71, v71, v83
    v_mul_f32 v72, v72, v83
    v_mul_f32 v73, v73, v83
    v_mul_f32 v74, v74, v83
    v_mul_f32 v75, v75, v83
    v_cvt_pk_bf16_f32 v62, 0, v62
    v_cvt_pk_bf16_f32 v63, 0, v63
    v_cvt_pk_bf16_f32 v64, 0, v64
    v_cvt_pk_bf16_f32 v65, 0, v65
    v_cvt_pk_bf16_f32 v66, 0, v66
    v_cvt_pk_bf16_f32 v67, 0, v67
    v_cvt_pk_bf16_f32 v68, 0, v68
    v_cvt_pk_bf16_f32 v69, 0, v69
    v_cvt_pk_bf16_f32 v70, 0, v70
    v_cvt_pk_bf16_f32 v71, 0, v71
    v_cvt_pk_bf16_f32 v72, 0, v72
    v_cvt_pk_bf16_f32 v73, 0, v73
    v_cvt_pk_bf16_f32 v74, 0, v74
    v_cvt_pk_bf16_f32 v75, 0, v75
    buffer_load_dwordx4 v[156:159], v6, s[64:67], s13 offen
    buffer_load_dwordx4 v[160:163], v6, s[64:67], s14 offen
    s_add_u32 s13, s13, 7168
    s_add_u32 s14, s14, 7168
    v_mul_f32 v62, v62, v20
    v_mul_f32 v63, v63, v21
    v_mul_f32 v64, v64, v22
    v_mul_f32 v65, v65, v23
    v_mul_f32 v66, v66, v24
    v_mul_f32 v67, v67, v25
    v_mul_f32 v68, v68, v26
    v_mul_f32 v69, v69, v27
    v_mul_f32 v70, v70, v28
    v_mul_f32 v71, v71, v29
    v_mul_f32 v72, v72, v30
    v_mul_f32 v73, v73, v31
    v_mul_f32 v74, v74, v32
    v_mul_f32 v75, v75, v33
    v_cvt_pk_bf16_f32 v62, 0, v62
    v_cvt_pk_bf16_f32 v63, 0, v63
    v_cvt_pk_bf16_f32 v64, 0, v64
    v_cvt_pk_bf16_f32 v65, 0, v65
    v_cvt_pk_bf16_f32 v66, 0, v66
    v_cvt_pk_bf16_f32 v67, 0, v67
    v_cvt_pk_bf16_f32 v68, 0, v68
    v_cvt_pk_bf16_f32 v69, 0, v69
    v_cvt_pk_bf16_f32 v70, 0, v70
    v_cvt_pk_bf16_f32 v71, 0, v71
    v_cvt_pk_bf16_f32 v72, 0, v72
    v_cvt_pk_bf16_f32 v73, 0, v73
    buffer_load_dwordx4 v[164:167], v6, s[64:67], s13 offen
    buffer_load_dwordx4 v[168:171], v6, s[64:67], s14 offen
    s_add_u32 s13, s13, 7168
    s_add_u32 s14, s14, 7168
    v_cvt_pk_bf16_f32 v74, 0, v74
    v_cvt_pk_bf16_f32 v75, 0, v75
    v_add_f32 v62, v62, v34
    v_add_f32 v63, v63, v35
    v_add_f32 v64, v64, v36
    v_add_f32 v65, v65, v37
    v_add_f32 v66, v66, v38
    v_add_f32 v67, v67, v39
    v_add_f32 v68, v68, v40
    v_add_f32 v69, v69, v41
    v_add_f32 v70, v70, v42
    v_add_f32 v71, v71, v43
    v_add_f32 v72, v72, v44
    v_add_f32 v73, v73, v45
    v_add_f32 v74, v74, v46
    v_add_f32 v75, v75, v47
    v_cvt_pk_bf16_f32 v91, v62, v63
    v_cvt_pk_bf16_f32 v92, v64, v65
    v_cvt_pk_bf16_f32 v93, v66, v67
    v_cvt_pk_bf16_f32 v94, v68, v69
    v_cvt_pk_bf16_f32 v95, v70, v71
    v_cvt_pk_bf16_f32 v96, v72, v73
    v_cvt_pk_bf16_f32 v97, v74, v75
    v_cvt_pk_bf16_f32 v62, 0, v62
    v_cvt_pk_bf16_f32 v63, 0, v63
    v_cvt_pk_bf16_f32 v64, 0, v64
    v_cvt_pk_bf16_f32 v65, 0, v65
    buffer_load_dwordx4 v[172:175], v6, s[64:67], s13 offen
    buffer_load_dwordx4 v[176:179], v6, s[64:67], s14 offen
    s_add_u32 s13, s13, 7168
    s_add_u32 s14, s14, 7168
    v_cvt_pk_bf16_f32 v66, 0, v66
    v_cvt_pk_bf16_f32 v67, 0, v67
    v_cvt_pk_bf16_f32 v68, 0, v68
    v_cvt_pk_bf16_f32 v69, 0, v69
    v_cvt_pk_bf16_f32 v70, 0, v70
    v_cvt_pk_bf16_f32 v71, 0, v71
    v_cvt_pk_bf16_f32 v72, 0, v72
    v_cvt_pk_bf16_f32 v73, 0, v73
    v_cvt_pk_bf16_f32 v74, 0, v74
    v_cvt_pk_bf16_f32 v75, 0, v75
    v_add_f32 v76, v62, v66
    v_add_f32 v77, v63, v67
    v_add_f32 v78, v64, v68
    v_add_f32 v79, v65, v69
    v_add_f32 v76, v76, v70
    v_add_f32 v77, v77, v71
    v_add_f32 v78, v78, v72
    v_add_f32 v79, v79, v73
    v_add_f32 v76, v76, v74
    v_add_f32 v77, v77, v75
    v_add_f32 v76, v76, v77
    v_add_f32 v78, v78, v79
    v_add_f32 v81, v76, v78
    s_nop 1
    v_add_f32_dpp v80, v81, v81 row_ror:8 row_mask:0xf bank_mask:0xf
    s_nop 1
    v_add_f32_dpp v81, v80, v80 row_ror:4 row_mask:0xf bank_mask:0xf
    s_nop 1
    v_add_f32_dpp v80, v81, v81 row_ror:2 row_mask:0xf bank_mask:0xf
    buffer_load_dwordx4 v[180:183], v6, s[64:67], s13 offen
    buffer_load_dwordx4 v[184:187], v6, s[64:67], s14 offen
    s_add_u32 s13, s13, 7168
    s_add_u32 s14, s14, 7168
    v_add_f32_dpp v81, v80, v80 row_ror:1 row_mask:0xf bank_mask:0xf
    v_mov_b32 v80, v81
    s_nop 1
    v_permlane16_swap_b32 v80, v81
    v_add_f32 v81, v81, v80
    v_mul_f32 v81, 0x3b124925, v81
    v_sub_f32 v80, v62, v81
    v_mul_f32 v76, v80, v80
    v_sub_f32 v82, v63, v81
    v_mul_f32 v77, v82, v82
    v_sub_f32 v80, v64, v81
    v_mul_f32 v78, v80, v80
    v_sub_f32 v82, v65, v81
    v_mul_f32 v79, v82, v82
    v_sub_f32 v80, v66, v81
    v_fmac_f32 v76, v80, v80
    v_sub_f32 v82, v67, v81
    v_fmac_f32 v77, v82, v82
    v_sub_f32 v80, v68, v81
    v_fmac_f32 v78, v80, v80
    v_sub_f32 v82, v69, v81
    v_fmac_f32 v79, v82, v82
    v_sub_f32 v80, v70, v81
    v_fmac_f32 v76, v80, v80
    v_sub_f32 v82, v71, v81
    v_fmac_f32 v77, v82, v82
    v_sub_f32 v80, v72, v81
    v_fmac_f32 v78, v80, v80
    buffer_load_dwordx4 v[188:191], v6, s[64:67], s13 offen
    buffer_load_dwordx4 v[192:195], v6, s[64:67], s14 offen
    s_add_u32 s13, s13, 7168
    s_add_u32 s14, s14, 7168
    v_sub_f32 v82, v73, v81
    v_fmac_f32 v79, v82, v82
    v_sub_f32 v80, v74, v81
    v_fmac_f32 v76, v80, v80
    v_sub_f32 v82, v75, v81
    v_fmac_f32 v77, v82, v82
    v_add_f32 v76, v76, v77
    v_add_f32 v78, v78, v79
    v_add_f32 v83, v76, v78
    s_nop 1
    v_add_f32_dpp v80, v83, v83 row_ror:8 row_mask:0xf bank_mask:0xf
    s_nop 1
    v_add_f32_dpp v83, v80, v80 row_ror:4 row_mask:0xf bank_mask:0xf
    s_nop 1
    v_add_f32_dpp v80, v83, v83 row_ror:2 row_mask:0xf bank_mask:0xf
    s_nop 1
    v_add_f32_dpp v83, v80, v80 row_ror:1 row_mask:0xf bank_mask:0xf
    v_mov_b32 v80, v83
    s_nop 1
    v_permlane16_swap_b32 v80, v83
    v_add_f32 v83, v83, v80
    v_mul_f32 v83, 0x3b124925, v83
    v_cvt_pk_bf16_f32 v83, 0, v83
    v_add_f32 v83, 0x3727c5ac, v83
    v_cvt_pk_bf16_f32 v83, 0, v83
    v_sqrt_f32 v83, v83
    s_nop 0
    v_cvt_pk_bf16_f32 v83, 0, v83
    v_rcp_f32 v83, v83
    v_cvt_pk_bf16_f32 v82, 0, v81
    v_sub_f32 v62, v62, v82
    v_sub_f32 v63, v63, v82
    buffer_load_dwordx4 v[196:199], v6, s[64:67], s13 offen
    buffer_load_dwordx4 v[200:203], v6, s[64:67], s14 offen
    s_add_u32 s13, s13, 7168
    s_add_u32 s14, s14, 7168
    v_sub_f32 v64, v64, v82
    v_sub_f32 v65, v65, v82
    v_sub_f32 v66, v66, v82
    v_sub_f32 v67, v67, v82
    v_sub_f32 v68, v68, v82
    v_sub_f32 v69, v69, v82
    v_sub_f32 v70, v70, v82
    v_sub_f32 v71, v71, v82
    v_sub_f32 v72, v72, v82
    v_sub_f32 v73, v73, v82
    v_sub_f32 v74, v74, v82
    v_sub_f32 v75, v75, v82
    v_cvt_pk_bf16_f32 v62, 0, v62
    v_cvt_pk_bf16_f32 v63, 0, v63
    v_cvt_pk_bf16_f32 v64, 0, v64
    v_cvt_pk_bf16_f32 v65, 0, v65
    v_cvt_pk_bf16_f32 v66, 0, v66
    v_cvt_pk_bf16_f32 v67, 0, v67
    v_cvt_pk_bf16_f32 v68, 0, v68
    v_cvt_pk_bf16_f32 v69, 0, v69
    v_cvt_pk_bf16_f32 v70, 0, v70
    v_cvt_pk_bf16_f32 v71, 0, v71
    v_cvt_pk_bf16_f32 v72, 0, v72
    v_cvt_pk_bf16_f32 v73, 0, v73
    v_cvt_pk_bf16_f32 v74, 0, v74
    v_cvt_pk_bf16_f32 v75, 0, v75
    v_mul_f32 v62, v62, v83
    buffer_load_dwordx4 v[204:207], v6, s[64:67], s13 offen
    buffer_load_dwordx4 v[208:211], v6, s[64:67], s14 offen
    s_add_u32 s13, s13, 7168
    s_add_u32 s14, s14, 7168
    v_mul_f32 v63, v63, v83
    v_mul_f32 v64, v64, v83
    v_mul_f32 v65, v65, v83
    v_mul_f32 v66, v66, v83
    v_mul_f32 v67, v67, v83
    v_mul_f32 v68, v68, v83
    v_mul_f32 v69, v69, v83
    v_mul_f32 v70, v70, v83
    v_mul_f32 v71, v71, v83
    v_mul_f32 v72, v72, v83
    v_mul_f32 v73, v73, v83
    v_mul_f32 v74, v74, v83
    v_mul_f32 v75, v75, v83
    v_cvt_pk_bf16_f32 v12, v62, v63
    v_cvt_pk_bf16_f32 v13, v64, v65
    v_cvt_pk_bf16_f32 v14, v66, v67
    v_cvt_pk_bf16_f32 v15, v68, v69
    v_cvt_pk_bf16_f32 v16, v70, v71
    v_cvt_pk_bf16_f32 v17, v72, v73
    v_cvt_pk_bf16_f32 v18, v74, v75
    ds_write_b32 v52, v12 offset:0
    ds_write_b32 v52, v13 offset:2048
    ds_write_b32 v52, v14 offset:4096
    ds_write_b32 v52, v15 offset:6144
    ds_write_b32 v52, v16 offset:8192
    ds_write_b32 v52, v17 offset:10240
    ds_write_b32 v52, v18 offset:12288
    s_cmp_eq_u32 s5, 1
    s_cselect_b64 vcc, -1, 0
    v_cndmask_b32 v84, v84, v91, vcc
    v_cndmask_b32 v85, v85, v92, vcc
    v_cndmask_b32 v86, v86, v93, vcc
    v_cndmask_b32 v87, v87, v94, vcc
    v_cndmask_b32 v88, v88, v95, vcc
    v_cndmask_b32 v89, v89, v96, vcc
    v_cndmask_b32 v90, v90, v97, vcc
    buffer_store_dword v84, v8, s[76:79], s15 offen offset:0 sc1
    buffer_store_dword v85, v8, s[76:79], s15 offen offset:128 sc1
    buffer_store_dword v86, v8, s[76:79], s15 offen offset:256 sc1
    buffer_store_dword v87, v8, s[76:79], s15 offen offset:384 sc1
    buffer_store_dword v88, v8, s[76:79], s15 offen offset:512 sc1
    buffer_store_dword v89, v8, s[76:79], s15 offen offset:640 sc1
    buffer_store_dword v90, v8, s[76:79], s15 offen offset:768 sc1
    v_lshrrev_b32 v50, 1, v3
    v_xor_b32 v50, v50, v4
    v_lshlrev_b32 v50, 4, v50
    v_lshl_add_u32 v48, v3, 7, v50
    v_xor_b32 v49, 64, v48
    v_mov_b32 v20, 0
    v_mov_b32 v21, 0
    v_mov_b32 v22, 0
    v_mov_b32 v23, 0
    v_mov_b32 v24, 0
    v_mov_b32 v25, 0
    v_mov_b32 v26, 0
    v_mov_b32 v27, 0
    s_add_u32 s72, s52, 13631488
    s_addc_u32 s73, s53, 0
    s_mov_b32 s74, 1835008
    s_mov_b32 s75, 0x00020000
    s_waitcnt lgkmcnt(0)
    s_barrier
    s_cmp_eq_u32 s7, 7
    s_cbranch_scc1 kb_kernel_st3
    ds_read_b128 v[28:31], v48 offset:0
    ds_read_b128 v[32:35], v49 offset:0
    ds_read_b128 v[36:39], v48 offset:2048
    ds_read_b128 v[40:43], v49 offset:2048
    ds_read_b128 v[44:47], v48 offset:4096
    s_waitcnt vmcnt(33) lgkmcnt(4)
    v_mfma_f32_16x16x32_bf16 v[20:23], v[100:103], v[28:31], v[20:23]
    v_mfma_f32_16x16x32_bf16 v[24:27], v[104:107], v[28:31], v[24:27]
    ds_read_b128 v[28:31], v49 offset:4096
    s_waitcnt vmcnt(31) lgkmcnt(4)
    v_mfma_f32_16x16x32_bf16 v[20:23], v[108:111], v[32:35], v[20:23]
    v_mfma_f32_16x16x32_bf16 v[24:27], v[112:115], v[32:35], v[24:27]
    ds_read_b128 v[32:35], v48 offset:6144
    s_waitcnt vmcnt(29) lgkmcnt(4)
    v_mfma_f32_16x16x32_bf16 v[20:23], v[116:119], v[36:39], v[20:23]
    v_mfma_f32_16x16x32_bf16 v[24:27], v[120:123], v[36:39], v[24:27]
    ds_read_b128 v[36:39], v49 offset:6144
    s_waitcnt vmcnt(27) lgkmcnt(4)
    v_mfma_f32_16x16x32_bf16 v[20:23], v[124:127], v[40:43], v[20:23]
    v_mfma_f32_16x16x32_bf16 v[24:27], v[128:131], v[40:43], v[24:27]
    ds_read_b128 v[40:43], v48 offset:8192
    s_waitcnt vmcnt(25) lgkmcnt(4)
    v_mfma_f32_16x16x32_bf16 v[20:23], v[132:135], v[44:47], v[20:23]
    v_mfma_f32_16x16x32_bf16 v[24:27], v[136:139], v[44:47], v[24:27]
    ds_read_b128 v[44:47], v49 offset:8192
    s_waitcnt vmcnt(23) lgkmcnt(4)
    v_mfma_f32_16x16x32_bf16 v[20:23], v[140:143], v[28:31], v[20:23]
    v_mfma_f32_16x16x32_bf16 v[24:27], v[144:147], v[28:31], v[24:27]
    ds_read_b128 v[28:31], v48 offset:10240
    s_waitcnt vmcnt(21) lgkmcnt(4)
    v_mfma_f32_16x16x32_bf16 v[20:23], v[148:151], v[32:35], v[20:23]
    v_mfma_f32_16x16x32_bf16 v[24:27], v[152:155], v[32:35], v[24:27]
    ds_read_b128 v[32:35], v49 offset:10240
    s_waitcnt vmcnt(19) lgkmcnt(4)
    v_mfma_f32_16x16x32_bf16 v[20:23], v[156:159], v[36:39], v[20:23]
    v_mfma_f32_16x16x32_bf16 v[24:27], v[160:163], v[36:39], v[24:27]
    ds_read_b128 v[36:39], v48 offset:12288
    s_waitcnt vmcnt(17) lgkmcnt(4)
    v_mfma_f32_16x16x32_bf16 v[20:23], v[164:167], v[40:43], v[20:23]
    v_mfma_f32_16x16x32_bf16 v[24:27], v[168:171], v[40:43], v[24:27]
    ds_read_b128 v[40:43], v49 offset:12288
    s_waitcnt vmcnt(15) lgkmcnt(4)
    v_mfma_f32_16x16x32_bf16 v[20:23], v[172:175], v[44:47], v[20:23]
    v_mfma_f32_16x16x32_bf16 v[24:27], v[176:179], v[44:47], v[24:27]
    s_waitcnt vmcnt(13) lgkmcnt(3)
    v_mfma_f32_16x16x32_bf16 v[20:23], v[180:183], v[28:31], v[20:23]
    v_mfma_f32_16x16x32_bf16 v[24:27], v[184:187], v[28:31], v[24:27]
    s_waitcnt vmcnt(11) lgkmcnt(2)
    v_mfma_f32_16x16x32_bf16 v[20:23], v[188:191], v[32:35], v[20:23]
    v_mfma_f32_16x16x32_bf16 v[24:27], v[192:195], v[32:35], v[24:27]
    s_waitcnt vmcnt(9) lgkmcnt(1)
    v_mfma_f32_16x16x32_bf16 v[20:23], v[196:199], v[36:39], v[20:23]
    v_mfma_f32_16x16x32_bf16 v[24:27], v[200:203], v[36:39], v[24:27]
    s_waitcnt vmcnt(7) lgkmcnt(0)
    v_mfma_f32_16x16x32_bf16 v[20:23], v[204:207], v[40:43], v[20:23]
    v_mfma_f32_16x16x32_bf16 v[24:27], v[208:211], v[40:43], v[24:27]
    v_mov_b32 v48, 0xc0135761
    v_mov_b32 v49, 0xbdd2d3e8
    v_and_b32 v50, 1, v4
    v_mul_u32_u24 v50, 3584, v50
    v_lshl_add_u32 v50, v2, 9, v50
    v_lshrrev_b32 v51, 1, v4
    v_lshl_add_u32 v50, v51, 8, v50
    v_lshl_add_u32 v50, v3, 4, v50
    s_mul_i32 s9, s5, 7168
    s_add_u32 s9, s9, s8
    v_cvt_pk_bf16_f32 v20, 0, v20
    v_cvt_pk_bf16_f32 v21, 0, v21
    v_cvt_pk_bf16_f32 v22, 0, v22
    v_cvt_pk_bf16_f32 v23, 0, v23
    v_cvt_pk_bf16_f32 v24, 0, v24
    v_cvt_pk_bf16_f32 v25, 0, v25
    v_cvt_pk_bf16_f32 v26, 0, v26
    v_cvt_pk_bf16_f32 v27, 0, v27
    v_mul_f32 v28, v20, v20
    v_mul_f32 v29, v21, v21
    v_mul_f32 v30, v22, v22
    v_mul_f32 v31, v23, v23
    v_mul_f32 v32, v24, v24
    v_mul_f32 v33, v25, v25
    v_mul_f32 v34, v26, v26
    v_mul_f32 v35, v27, v27
    v_fma_f32 v28, v28, v49, v48
    v_fma_f32 v29, v29, v49, v48
    v_fma_f32 v30, v30, v49, v48
    v_fma_f32 v31, v31, v49, v48
    v_fma_f32 v32, v32, v49, v48
    v_fma_f32 v33, v33, v49, v48
    v_fma_f32 v34, v34, v49, v48
    v_fma_f32 v35, v35, v49, v48
    v_mul_f32 v28, v28, v20
    v_mul_f32 v29, v29, v21
    v_mul_f32 v30, v30, v22
    v_mul_f32 v31, v31, v23
    v_mul_f32 v32, v32, v24
    v_mul_f32 v33, v33, v25
    v_mul_f32 v34, v34, v26
    v_mul_f32 v35, v35, v27
    v_exp_f32 v28, v28
    v_exp_f32 v29, v29
    v_exp_f32 v30, v30
    v_exp_f32 v31, v31
    v_exp_f32 v32, v32
    v_exp_f32 v33, v33
    v_exp_f32 v34, v34
    v_exp_f32 v35, v35
    v_add_f32 v28, 1.0, v28
    v_add_f32 v29, 1.0, v29
    v_add_f32 v30, 1.0, v30
    v_add_f32 v31, 1.0, v31
    v_add_f32 v32, 1.0, v32
    v_add_f32 v33, 1.0, v33
    v_add_f32 v34, 1.0, v34
    v_add_f32 v35, 1.0, v35
    v_rcp_f32 v28, v28
    v_rcp_f32 v29, v29
    v_rcp_f32 v30, v30
    v_rcp_f32 v31, v31
    v_rcp_f32 v32, v32
    v_rcp_f32 v33, v33
    v_rcp_f32 v34, v34
    v_rcp_f32 v35, v35
    v_mul_f32 v20, v20, v28
    v_mul_f32 v21, v21, v29
    v_mul_f32 v22, v22, v30
    v_mul_f32 v23, v23, v31
    v_mul_f32 v24, v24, v32
    v_mul_f32 v25, v25, v33
    v_mul_f32 v26, v26, v34
    v_mul_f32 v27, v27, v35
    v_cvt_pk_bf16_f32 v36, v20, v21
    v_cvt_pk_bf16_f32 v37, v22, v23
    v_cvt_pk_bf16_f32 v38, v24, v25
    v_cvt_pk_bf16_f32 v39, v26, v27
    s_nop 0
    v_permlane16_swap_b32 v36, v38
    v_permlane16_swap_b32 v37, v39
    buffer_store_dwordx4 v[36:39], v50, s[72:75], s9 offen sc1
kb_kernel_st3:
    s_waitcnt vmcnt(0)
    s_cmp_lg_u32 s7, 0
    s_cbranch_scc1 kb_kernel_tk4
    v_readfirstlane_b32 s22, v248
    s_nop 0
    s_cmp_lt_u32 s22, 32
    s_nop 2
    s_cbranch_scc1 kb_kernel_tkok5
    v_mov_b32 v248, 1
    v_mov_b32 v249, 0
    s_mov_b32 s22, 283648
    s_mov_b64 s[96:97], exec
    s_mov_b64 exec, 1
    buffer_atomic_add v248, v249, s[92:95], s22 offen sc0 sc1
    s_mov_b64 exec, s[96:97]
    v_lshlrev_b32 v249, 7, v1
    v_add_u32 v249, 282624, v249
    s_waitcnt vmcnt(0)
    v_readfirstlane_b32 s23, v248
    s_mov_b32 s98, 0x200000
kb_kernel_tkw6:
    buffer_load_dword v248, v249, s[92:95], 0 offen sc1
    s_waitcnt vmcnt(0)
    s_mov_b32 s24, 0
    v_readlane_b32 s25, v248, 0
    s_nop 0
    s_add_u32 s24, s24, s25
    v_readlane_b32 s25, v248, 1
    s_nop 0
    s_add_u32 s24, s24, s25
    v_readlane_b32 s25, v248, 2
    s_nop 0
    s_add_u32 s24, s24, s25
    v_readlane_b32 s25, v248, 3
    s_nop 0
    s_add_u32 s24, s24, s25
    v_readlane_b32 s25, v248, 4
    s_nop 0
    s_add_u32 s24, s24, s25
    v_readlane_b32 s25, v248, 5
    s_nop 0
    s_add_u32 s24, s24, s25
    v_readlane_b32 s25, v248, 6
    s_nop 0
    s_add_u32 s24, s24, s25
    v_readlane_b32 s25, v248, 7
    s_nop 0
    s_add_u32 s24, s24, s25
    s_sub_u32 s98, s98, 1
    s_cmp_eq_u32 s98, 0
    s_nop 0
    s_cbranch_scc1 kb_kernel_tkx7
    s_cmp_lt_u32 s24, 256
    s_cbranch_scc1 kb_kernel_tkw6
kb_kernel_tkx7:
    s_mov_b32 s21, 0
    s_mov_b32 s22, 0
    v_readlane_b32 s25, v248, 0
    s_nop 0
    s_min_u32 s25, s25, 32
    s_sub_u32 s24, 32, s25
    s_mov_b32 s21, 0
    s_add_u32 s22, s25, s23
    s_cmp_lt_u32 s23, s24
    s_cbranch_scc1 kb_kernel_tkok5
    s_sub_u32 s23, s23, s24
    v_readlane_b32 s25, v248, 1
    s_nop 0
    s_min_u32 s25, s25, 32
    s_sub_u32 s24, 32, s25
    s_mov_b32 s21, 1
    s_add_u32 s22, s25, s23
    s_cmp_lt_u32 s23, s24
    s_cbranch_scc1 kb_kernel_tkok5
    s_sub_u32 s23, s23, s24
    v_readlane_b32 s25, v248, 2
    s_nop 0
    s_min_u32 s25, s25, 32
    s_sub_u32 s24, 32, s25
    s_mov_b32 s21, 2
    s_add_u32 s22, s25, s23
    s_cmp_lt_u32 s23, s24
    s_cbranch_scc1 kb_kernel_tkok5
    s_sub_u32 s23, s23, s24
    v_readlane_b32 s25, v248, 3
    s_nop 0
    s_min_u32 s25, s25, 32
    s_sub_u32 s24, 32, s25
    s_mov_b32 s21, 3
    s_add_u32 s22, s25, s23
    s_cmp_lt_u32 s23, s24
    s_cbranch_scc1 kb_kernel_tkok5
    s_sub_u32 s23, s23, s24
    v_readlane_b32 s25, v248, 4
    s_nop 0
    s_min_u32 s25, s25, 32
    s_sub_u32 s24, 32, s25
    s_mov_b32 s21, 4
    s_add_u32 s22, s25, s23
    s_cmp_lt_u32 s23, s24
    s_cbranch_scc1 kb_kernel_tkok5
    s_sub_u32 s23, s23, s24
    v_readlane_b32 s25, v248, 5
    s_nop 0
    s_min_u32 s25, s25, 32
    s_sub_u32 s24, 32, s25
    s_mov_b32 s21, 5
    s_add_u32 s22, s25, s23
    s_cmp_lt_u32 s23, s24
    s_cbranch_scc1 kb_kernel_tkok5
    s_sub_u32 s23, s23, s24
    v_readlane_b32 s25, v248, 6
    s_nop 0
    s_min_u32 s25, s25, 32
    s_sub_u32 s24, 32, s25
    s_mov_b32 s21, 6
    s_add_u32 s22, s25, s23
    s_cmp_lt_u32 s23, s24
    s_cbranch_scc1 kb_kernel_tkok5
    s_sub_u32 s23, s23, s24
    v_readlane_b32 s25, v248, 7
    s_nop 0
    s_min_u32 s25, s25, 32
    s_sub_u32 s24, 32, s25
    s_mov_b32 s21, 7
    s_add_u32 s22, s25, s23
    s_cmp_lt_u32 s23, s24
    s_cbranch_scc1 kb_kernel_tkok5
    s_sub_u32 s23, s23, s24
kb_kernel_tkok5:
    s_lshl_b32 s22, s22, 3
    s_or_b32 s22, s22, s21
    v_mov_b32 v248, s22
    v_mov_b32 v249, 115712
    ds_write_b32 v249, v248
kb_kernel_tk4:
    s_waitcnt lgkmcnt(0)
    s_barrier
    s_cmp_lg_u32 s7, 0
    s_cbranch_scc1 kb_kernel_arr9
    v_mov_b32 v250, 1
    v_mov_b32 v251, 0
    s_mov_b64 s[96:97], exec
    s_mov_b64 exec, 1
    buffer_atomic_add v250, v251, s[92:95], s99 offen sc1
    s_mov_b64 exec, s[96:97]
kb_kernel_arr9:
    v_mov_b32 v249, 115712
    ds_read_b32 v248, v249
    s_waitcnt lgkmcnt(0)
    v_readfirstlane_b32 s2, v248
    s_nop 0
    s_and_b32 s2, s2, 255
    s_cmp_eq_u32 s7, 7
    s_nop 1
    s_cbranch_scc1 kb_kernel_nw10
    s_add_u32 s80, s52, 26738688
    s_addc_u32 s81, s53, 0
    s_mov_b32 s82, 401408
    s_mov_b32 s83, 0x00020000
    s_lshr_b32 s77, s2, 3
    s_and_b32 s77, s77, 3
    s_mul_i32 s77, s77, 100352
    buffer_load_dwordx4 v[100:103], v6, s[80:83], s77 offen
    s_add_u32 s77, s77, 7168
    buffer_load_dwordx4 v[104:107], v6, s[80:83], s77 offen
    s_add_u32 s77, s77, 7168
    buffer_load_dwordx4 v[108:111], v6, s[80:83], s77 offen
    s_add_u32 s77, s77, 7168
    buffer_load_dwordx4 v[112:115], v6, s[80:83], s77 offen
    s_add_u32 s77, s77, 7168
    buffer_load_dwordx4 v[116:119], v6, s[80:83], s77 offen
    s_add_u32 s77, s77, 7168
    buffer_load_dwordx4 v[120:123], v6, s[80:83], s77 offen
    s_add_u32 s77, s77, 7168
    buffer_load_dwordx4 v[124:127], v6, s[80:83], s77 offen
    s_add_u32 s77, s77, 7168
    buffer_load_dwordx4 v[128:131], v6, s[80:83], s77 offen
    s_add_u32 s77, s77, 7168
    buffer_load_dwordx4 v[132:135], v6, s[80:83], s77 offen
    s_add_u32 s77, s77, 7168
    buffer_load_dwordx4 v[136:139], v6, s[80:83], s77 offen
    s_add_u32 s77, s77, 7168
    buffer_load_dwordx4 v[140:143], v6, s[80:83], s77 offen
    s_add_u32 s77, s77, 7168
    buffer_load_dwordx4 v[144:147], v6, s[80:83], s77 offen
    s_add_u32 s77, s77, 7168
    buffer_load_dwordx4 v[148:151], v6, s[80:83], s77 offen
    s_add_u32 s77, s77, 7168
    buffer_load_dwordx4 v[152:155], v6, s[80:83], s77 offen
    s_add_u32 s77, s77, 7168
kb_kernel_nw10:
    s_and_b32 s4, s2, 7
    s_lshr_b32 s5, s2, 3
    s_lshl_b32 s4, s4, 3
    s_lshr_b32 s6, s5, 2
    s_add_u32 s4, s4, s6
    s_lshl_b32 s4, s4, 5
    s_and_b32 s5, s5, 3
    s_mul_i32 s6, s5, 112
    s_lshl_b32 s9, s6, 1
    v_lshlrev_b32 v7, 4, v0
    s_mul_i32 s13, s5, 100352
    s_lshr_b32 s99, s4, 7
    s_lshl_b32 s99, s99, 7
    s_add_u32 s99, s99, 278528
    v_add_u32 v8, 0, v0
    v_cmp_lt_u32 vcc, 895, v8
    s_nop 1
    v_cndmask_b32 v5, 0, 1, vcc
    v_mul_u32_u24 v6, 896, v5
    v_sub_u32 v8, v8, v6
    v_lshrrev_b32 v8, 4, v8
    v_mul_u32_u24 v9, 0x12493, v8
    v_lshrrev_b32 v9, 20, v9
    v_lshrrev_b32 v14, 1, v9
    v_add_u32 v14, 1, v14
    v_and_b32 v9, 1, v9
    v_lshlrev_b32 v9, 1, v9
    v_subrev_u32 v9, 1, v9
    v_mul_i32_i24 v9, v9, v14
    v_lshl_add_u32 v9, v5, 4, v9
    v_add_u32 v9, v9, v3
    v_add_u32 v9, s4, v9
    v_ashrrev_i32 v14, 4, v9
    v_mul_i32_i24 v10, 14336, v14
    v_and_b32 v9, 15, v9
    v_lshl_add_u32 v10, v9, 4, v10
    v_lshl_add_u32 v10, v8, 8, v10
    v_add_u32 v8, 512, v0
    v_cmp_lt_u32 vcc, 895, v8
    s_nop 1
    v_cndmask_b32 v5, 0, 1, vcc
    v_mul_u32_u24 v6, 896, v5
    v_sub_u32 v8, v8, v6
    v_lshrrev_b32 v8, 4, v8
    v_mul_u32_u24 v9, 0x12493, v8
    v_lshrrev_b32 v9, 20, v9
    v_lshrrev_b32 v14, 1, v9
    v_add_u32 v14, 1, v14
    v_and_b32 v9, 1, v9
    v_lshlrev_b32 v9, 1, v9
    v_subrev_u32 v9, 1, v9
    v_mul_i32_i24 v9, v9, v14
    v_lshl_add_u32 v9, v5, 4, v9
    v_add_u32 v9, v9, v3
    v_add_u32 v9, s4, v9
    v_ashrrev_i32 v14, 4, v9
    v_mul_i32_i24 v11, 14336, v14
    v_and_b32 v9, 15, v9
    v_lshl_add_u32 v11, v9, 4, v11
    v_lshl_add_u32 v11, v8, 8, v11
    v_add_u32 v8, 1024, v0
    v_cmp_lt_u32 vcc, 895, v8
    s_nop 1
    v_cndmask_b32 v5, 0, 1, vcc
    v_mul_u32_u24 v6, 896, v5
    v_sub_u32 v8, v8, v6
    v_lshrrev_b32 v8, 4, v8
    v_mul_u32_u24 v9, 0x12493, v8
    v_lshrrev_b32 v9, 20, v9
    v_lshrrev_b32 v14, 1, v9
    v_add_u32 v14, 1, v14
    v_and_b32 v9, 1, v9
    v_lshlrev_b32 v9, 1, v9
    v_subrev_u32 v9, 1, v9
    v_mul_i32_i24 v9, v9, v14
    v_lshl_add_u32 v9, v5, 4, v9
    v_add_u32 v9, v9, v3
    v_add_u32 v9, s4, v9
    v_ashrrev_i32 v14, 4, v9
    v_mul_i32_i24 v12, 14336, v14
    v_and_b32 v9, 15, v9
    v_lshl_add_u32 v12, v9, 4, v12
    v_lshl_add_u32 v12, v8, 8, v12
    v_add_u32 v8, 1536, v0
    v_cmp_lt_u32 vcc, 895, v8
    s_nop 1
    v_cndmask_b32 v5, 0, 1, vcc
    v_mul_u32_u24 v6, 896, v5
    v_sub_u32 v8, v8, v6
    v_lshrrev_b32 v8, 4, v8
    v_mul_u32_u24 v9, 0x12493, v8
    v_lshrrev_b32 v9, 20, v9
    v_lshrrev_b32 v14, 1, v9
    v_add_u32 v14, 1, v14
    v_and_b32 v9, 1, v9
    v_lshlrev_b32 v9, 1, v9
    v_subrev_u32 v9, 1, v9
    v_mul_i32_i24 v9, v9, v14
    v_lshl_add_u32 v9, v5, 4, v9
    v_add_u32 v9, v9, v3
    v_add_u32 v9, s4, v9
    v_ashrrev_i32 v14, 4, v9
    v_mul_i32_i24 v13, 14336, v14
    v_and_b32 v9, 15, v9
    v_lshl_add_u32 v13, v9, 4, v13
    v_lshl_add_u32 v13, v8, 8, v13
    v_mov_b32 v8, 0x7ff00000
    v_cmp_lt_u32 vcc, 3, v2
    s_nop 1
    v_cndmask_b32 v13, v13, v8, vcc
    v_add_u32 v15, s4, v3
    v_mul_u32_u24 v15, 896, v15
    v_lshl_add_u32 v15, v4, 3, v15
    v_lshl_add_u32 v15, v2, 5, v15
    s_lshr_b32 s10, s4, 4
    v_add_u32 v20, s10, v1
    v_subrev_u32 v20, 1, v20
    v_max_i32 v20, 0, v20
    v_min_i32 v20, 127, v20
    v_lshlrev_b32 v20, 7, v20
    v_add_u32 v20, 262144, v20
    s_add_u32 s56, s52, 13631488
    s_addc_u32 s57, s53, 0
    s_mov_b32 s58, 1835008
    s_mov_b32 s59, 0x00020000
    s_add_u32 s60, s52, 11534336
    s_addc_u32 s61, s53, 0
    s_mov_b32 s62, 1835008
    s_mov_b32 s63, 0x00020000
    s_add_u32 s68, s52, 15728640
    s_addc_u32 s69, s53, 0
    s_mov_b32 s70, 1835008
    s_mov_b32 s71, 0x00020000
    s_add_u32 s72, s52, 65536
    s_addc_u32 s73, s53, 0
    s_mov_b32 s74, 65536
    s_mov_b32 s75, 0x00020000
    v_lshrrev_b32 v83, 1, v4
    v_lshlrev_b32 v81, 9, v83
    v_and_b32 v83, 1, v4
    v_lshl_add_u32 v81, v83, 8, v81
    v_lshl_add_u32 v81, v3, 4, v81
    v_and_b32 v82, 1, v4
    v_mul_u32_u24 v82, 14336, v82
    v_lshl_add_u32 v82, v2, 9, v82
    v_lshrrev_b32 v83, 1, v4
    v_lshl_add_u32 v82, v83, 8, v82
    v_lshl_add_u32 v82, v3, 4, v82
    s_mul_i32 s12, s4, 896
    s_mul_i32 s13, s5, 3584
    s_add_u32 s12, s12, s13
    v_mov_b32 v24, 0
    v_mov_b32 v25, 0
    v_mov_b32 v26, 0
    v_mov_b32 v27, 0
    v_mov_b32 v28, 0
    v_mov_b32 v29, 0
    v_mov_b32 v30, 0
    v_mov_b32 v31, 0
    s_lshl_b32 s11, s7, 10
    s_add_u32 s10, s9, 14336
    s_cmp_lg_u32 s7, 7
    s_cbranch_scc1 kb_kernel_polld12
    s_mov_b64 s[96:97], exec
    s_mov_b64 exec, 15
    s_mov_b32 s98, 0x200000
kb_kernel_poll11:
    buffer_load_dword v250, v20, s[92:95], 0 offen sc1
    s_waitcnt vmcnt(0)
    v_cmp_gt_u32 vcc, 2, v250
    s_sub_u32 s98, s98, 1
    s_cmp_eq_u32 s98, 0
    s_nop 2
    s_cbranch_scc1 kb_kernel_polld12_x
    s_cbranch_vccz kb_kernel_polld12_x
    s_sleep 1
    s_branch kb_kernel_poll11
kb_kernel_polld12_x:
    s_mov_b64 exec, s[96:97]
kb_kernel_polld12:
    s_barrier
    s_add_u32 m0, s11, 0
    s_nop 0
    buffer_load_dwordx4 v10, s[56:59], 0 offen sc1 lds
    s_add_u32 m0, s11, 8192
    s_nop 0
    buffer_load_dwordx4 v11, s[56:59], 0 offen sc1 lds
    s_add_u32 m0, s11, 16384
    s_nop 0
    buffer_load_dwordx4 v12, s[56:59], 0 offen sc1 lds
    s_add_u32 m0, s11, 24576
    s_nop 0
    buffer_load_dwordx4 v13, s[56:59], 0 offen sc1 lds
    s_cmp_eq_u32 s7, 7
    s_cbranch_scc1 kb_kernel_w713
    buffer_load_dwordx2 v[16:17], v15, s[60:63], s9 offen sc1
    buffer_load_dwordx2 v[18:19], v15, s[60:63], s10 offen sc1
    s_waitcnt vmcnt(2)
    s_barrier
    ds_read_b128 v[32:35], v81 offset:0
    ds_read_b128 v[36:39], v81 offset:14336
    ds_read_b128 v[40:43], v81 offset:1024
    ds_read_b128 v[44:47], v81 offset:15360
    ds_read_b128 v[48:51], v81 offset:2048
    ds_read_b128 v[52:55], v81 offset:16384
    ds_read_b128 v[56:59], v81 offset:3072
    ds_read_b128 v[60:63], v81 offset:17408
    ds_read_b128 v[64:67], v81 offset:4096
    ds_read_b128 v[68:71], v81 offset:18432
    ds_read_b128 v[72:75], v81 offset:5120
    ds_read_b128 v[76:79], v81 offset:19456
    s_waitcnt lgkmcnt(10)
    v_mfma_f32_16x16x32_bf16 v[24:27], v[100:103], v[32:35], v[24:27]
    v_mfma_f32_16x16x32_bf16 v[28:31], v[100:103], v[36:39], v[28:31]
    ds_read_b128 v[32:35], v81 offset:6144
    ds_read_b128 v[36:39], v81 offset:20480
    s_waitcnt lgkmcnt(10)
    v_mfma_f32_16x16x32_bf16 v[24:27], v[104:107], v[40:43], v[24:27]
    v_mfma_f32_16x16x32_bf16 v[28:31], v[104:107], v[44:47], v[28:31]
    ds_read_b128 v[40:43], v81 offset:7168
    ds_read_b128 v[44:47], v81 offset:21504
    s_waitcnt lgkmcnt(10)
    v_mfma_f32_16x16x32_bf16 v[24:27], v[108:111], v[48:51], v[24:27]
    v_mfma_f32_16x16x32_bf16 v[28:31], v[108:111], v[52:55], v[28:31]
    ds_read_b128 v[48:51], v81 offset:8192
    ds_read_b128 v[52:55], v81 offset:22528
    s_waitcnt lgkmcnt(10)
    v_mfma_f32_16x16x32_bf16 v[24:27], v[112:115], v[56:59], v[24:27]
    v_mfma_f32_16x16x32_bf16 v[28:31], v[112:115], v[60:63], v[28:31]
    ds_read_b128 v[56:59], v81 offset:9216
    ds_read_b128 v[60:63], v81 offset:23552
    s_waitcnt lgkmcnt(10)
    v_mfma_f32_16x16x32_bf16 v[24:27], v[116:119], v[64:67], v[24:27]
    v_mfma_f32_16x16x32_bf16 v[28:31], v[116:119], v[68:71], v[28:31]
    ds_read_b128 v[64:67], v81 offset:10240
    ds_read_b128 v[68:71], v81 offset:24576
    s_waitcnt lgkmcnt(10)
    v_mfma_f32_16x16x32_bf16 v[24:27], v[120:123], v[72:75], v[24:27]
    v_mfma_f32_16x16x32_bf16 v[28:31], v[120:123], v[76:79], v[28:31]
    ds_read_b128 v[72:75], v81 offset:11264
    ds_read_b128 v[76:79], v81 offset:25600
    s_waitcnt lgkmcnt(10)
    v_mfma_f32_16x16x32_bf16 v[24:27], v[124:127], v[32:35], v[24:27]
    v_mfma_f32_16x16x32_bf16 v[28:31], v[124:127], v[36:39], v[28:31]
    ds_read_b128 v[32:35], v81 offset:12288
    ds_read_b128 v[36:39], v81 offset:26624
    s_waitcnt lgkmcnt(10)
    v_mfma_f32_16x16x32_bf16 v[24:27], v[128:131], v[40:43], v[24:27]
    v_mfma_f32_16x16x32_bf16 v[28:31], v[128:131], v[44:47], v[28:31]
    ds_read_b128 v[40:43], v81 offset:13312
    ds_read_b128 v[44:47], v81 offset:27648
    s_waitcnt lgkmcnt(10)
    v_mfma_f32_16x16x32_bf16 v[24:27], v[132:135], v[48:51], v[24:27]
    v_mfma_f32_16x16x32_bf16 v[28:31], v[132:135], v[52:55], v[28:31]
    s_waitcnt lgkmcnt(8)
    v_mfma_f32_16x16x32_bf16 v[24:27], v[136:139], v[56:59], v[24:27]
    v_mfma_f32_16x16x32_bf16 v[28:31], v[136:139], v[60:63], v[28:31]
    s_waitcnt lgkmcnt(6)
    v_mfma_f32_16x16x32_bf16 v[24:27], v[140:143], v[64:67], v[24:27]
    v_mfma_f32_16x16x32_bf16 v[28:31], v[140:143], v[68:71], v[28:31]
    s_waitcnt lgkmcnt(4)
    v_mfma_f32_16x16x32_bf16 v[24:27], v[144:147], v[72:75], v[24:27]
    v_mfma_f32_16x16x32_bf16 v[28:31], v[144:147], v[76:79], v[28:31]
    s_waitcnt lgkmcnt(2)
    v_mfma_f32_16x16x32_bf16 v[24:27], v[148:151], v[32:35], v[24:27]
    v_mfma_f32_16x16x32_bf16 v[28:31], v[148:151], v[36:39], v[28:31]
    s_waitcnt lgkmcnt(0)
    v_mfma_f32_16x16x32_bf16 v[24:27], v[152:155], v[40:43], v[24:27]
    v_mfma_f32_16x16x32_bf16 v[28:31], v[152:155], v[44:47], v[28:31]
    v_mul_u32_u24 v84, 56, v3
    v_lshl_add_u32 v84, v2, 3, v84
    v_add_u32 v84, 32768, v84
    s_waitcnt vmcnt(0)
    s_nop 2
    v_cvt_pk_bf16_f32 v24, 0, v24
    v_cvt_pk_bf16_f32 v25, 0, v25
    v_cvt_pk_bf16_f32 v26, 0, v26
    v_cvt_pk_bf16_f32 v27, 0, v27
    v_lshlrev_b32 v42, 16, v16
    v_and_b32 v43, 0xffff0000, v16
    v_lshlrev_b32 v44, 16, v17
    v_and_b32 v45, 0xffff0000, v17
    v_add_f32 v24, v24, v42
    v_add_f32 v25, v25, v43
    v_add_f32 v26, v26, v44
    v_add_f32 v27, v27, v45
    v_cvt_pk_bf16_f32 v46, v24, v25
    v_cvt_pk_bf16_f32 v47, v26, v27
    v_cvt_pk_bf16_f32 v28, 0, v28
    v_cvt_pk_bf16_f32 v29, 0, v29
    v_cvt_pk_bf16_f32 v30, 0, v30
    v_cvt_pk_bf16_f32 v31, 0, v31
    v_lshlrev_b32 v42, 16, v18
    v_and_b32 v43, 0xffff0000, v18
    v_lshlrev_b32 v44, 16, v19
    v_and_b32 v45, 0xffff0000, v19
    v_add_f32 v28, v28, v42
    v_add_f32 v29, v29, v43
    v_add_f32 v30, v30, v44
    v_add_f32 v31, v31, v45
    v_cvt_pk_bf16_f32 v48, v28, v29
    v_cvt_pk_bf16_f32 v49, v30, v31
    s_nop 0
    v_permlane16_swap_b32 v46, v48
    v_permlane16_swap_b32 v47, v49
    buffer_store_dwordx4 v[46:49], v82, s[68:71], s12 offen sc1
    v_cvt_pk_bf16_f32 v24, 0, v24
    v_cvt_pk_bf16_f32 v25, 0, v25
    v_cvt_pk_bf16_f32 v26, 0, v26
    v_cvt_pk_bf16_f32 v27, 0, v27
    v_add_f32 v50, v24, v25
    v_add_f32 v51, v26, v27
    v_add_f32 v50, v50, v51
    v_mov_b32 v52, v50
    s_nop 1
    v_permlane32_swap_b32 v52, v50
    v_add_f32 v50, v50, v52
    v_mov_b32 v52, v50
    s_nop 1
    v_permlane16_swap_b32 v52, v50
    v_add_f32 v50, v50, v52
    v_mul_f32 v50, 0x3d800000, v50
    v_sub_f32 v42, v24, v50
    v_sub_f32 v43, v25, v50
    v_sub_f32 v44, v26, v50
    v_sub_f32 v45, v27, v50
    v_mul_f32 v51, v42, v42
    v_fmac_f32 v51, v43, v43
    v_fmac_f32 v51, v44, v44
    v_fmac_f32 v51, v45, v45
    v_mov_b32 v52, v51
    s_nop 1
    v_permlane32_swap_b32 v52, v51
    v_add_f32 v51, v51, v52
    v_mov_b32 v52, v51
    s_nop 1
    v_permlane16_swap_b32 v52, v51
    v_add_f32 v51, v51, v52
    ds_write_b64 v84, v[50:51] offset:0
    v_cvt_pk_bf16_f32 v28, 0, v28
    v_cvt_pk_bf16_f32 v29, 0, v29
    v_cvt_pk_bf16_f32 v30, 0, v30
    v_cvt_pk_bf16_f32 v31, 0, v31
    v_add_f32 v50, v28, v29
    v_add_f32 v51, v30, v31
    v_add_f32 v50, v50, v51
    v_mov_b32 v52, v50
    s_nop 1
    v_permlane32_swap_b32 v52, v50
    v_add_f32 v50, v50, v52
    v_mov_b32 v52, v50
    s_nop 1
    v_permlane16_swap_b32 v52, v50
    v_add_f32 v50, v50, v52
    v_mul_f32 v50, 0x3d800000, v50
    v_sub_f32 v42, v28, v50
    v_sub_f32 v43, v29, v50
    v_sub_f32 v44, v30, v50
    v_sub_f32 v45, v31, v50
    v_mul_f32 v51, v42, v42
    v_fmac_f32 v51, v43, v43
    v_fmac_f32 v51, v44, v44
    v_fmac_f32 v51, v45, v45
    v_mov_b32 v52, v51
    s_nop 1
    v_permlane32_swap_b32 v52, v51
    v_add_f32 v51, v51, v52
    v_mov_b32 v52, v51
    s_nop 1
    v_permlane16_swap_b32 v52, v51
    v_add_f32 v51, v51, v52
    ds_write_b64 v84, v[50:51] offset:896
    s_waitcnt vmcnt(0)
    s_waitcnt lgkmcnt(0)
    s_barrier
    s_cmp_lg_u32 s7, 0
    s_cbranch_scc1 kb_kernel_arr15
    v_mov_b32 v250, 1
    v_mov_b32 v251, 0
    s_mov_b64 s[96:97], exec
    s_mov_b64 exec, 1
    buffer_atomic_add v250, v251, s[92:95], s99 offen sc1
    s_mov_b64 exec, s[96:97]
kb_kernel_arr15:
    s_branch kb_kernel_j414
kb_kernel_w713:
    s_waitcnt vmcnt(0)
    s_barrier
    v_and_b32 v5, 31, v1
    v_mul_u32_u24 v6, 56, v5
    v_add_u32 v6, 32768, v6
    v_add_u32 v7, s4, v5
    v_lshlrev_b32 v7, 5, v7
    s_lshl_b32 s10, s5, 3
    s_barrier
    ds_read_b64 v[10:11], v6 offset:0
    ds_read_b64 v[12:13], v6 offset:8
    ds_read_b64 v[14:15], v6 offset:16
    ds_read_b64 v[16:17], v6 offset:24
    ds_read_b64 v[18:19], v6 offset:32
    ds_read_b64 v[20:21], v6 offset:40
    ds_read_b64 v[22:23], v6 offset:48
    s_waitcnt lgkmcnt(0)
    v_add_f32 v24, v10, v12
    v_add_f32 v25, v14, v16
    v_add_f32 v26, v18, v20
    v_add_f32 v24, v24, v22
    v_add_f32 v25, v25, v26
    v_add_f32 v24, v24, v25
    v_mul_f32 v24, 0x3e124925, v24
    v_add_f32 v25, v11, v13
    v_add_f32 v26, v15, v17
    v_add_f32 v27, v19, v21
    v_add_f32 v25, v25, v23
    v_add_f32 v26, v26, v27
    v_add_f32 v25, v25, v26
    v_mov_b32 v26, 0
    v_sub_f32 v27, v10, v24
    v_fmac_f32 v26, v27, v27
    v_sub_f32 v27, v12, v24
    v_fmac_f32 v26, v27, v27
    v_sub_f32 v27, v14, v24
    v_fmac_f32 v26, v27, v27
    v_sub_f32 v27, v16, v24
    v_fmac_f32 v26, v27, v27
    v_sub_f32 v27, v18, v24
    v_fmac_f32 v26, v27, v27
    v_sub_f32 v27, v20, v24
    v_fmac_f32 v26, v27, v27
    v_sub_f32 v27, v22, v24
    v_fmac_f32 v26, v27, v27
    v_fmac_f32 v25, 0x41800000, v26
    buffer_store_dwordx2 v[24:25], v7, s[72:75], s10 offen sc1
    s_add_u32 s99, s99, 5248
    v_mov_b32 v250, 1
    v_mov_b32 v251, 0
    s_waitcnt vmcnt(0)
    s_mov_b64 s[96:97], exec
    s_mov_b64 exec, 1
    buffer_atomic_add v250, v251, s[92:95], s99 offen sc1
    s_mov_b64 exec, s[96:97]
kb_kernel_j414:
    s_cmp_eq_u32 s7, 7
    s_cbranch_scc1 kb_kernel_nw16
    s_add_u32 s80, s52, 27262976
    s_addc_u32 s81, s53, 0
    s_mov_b32 s82, 1605632
    s_mov_b32 s83, 0x00020000
    s_add_u32 s64, s52, 16384
    s_addc_u32 s65, s53, 0
    s_mov_b32 s66, 7168
    s_mov_b32 s67, 0x00020000
    s_lshr_b32 s77, s2, 3
    s_and_b32 s77, s77, 15
    s_mul_i32 s78, s77, 448
    s_mul_i32 s77, s77, 100352
    v_lshlrev_b32 v85, 4, v4
    v_lshl_add_u32 v85, v2, 6, v85
    buffer_load_dwordx4 v[160:163], v7, s[80:83], s77 offen
    s_add_u32 s77, s77, 7168
    buffer_load_dwordx4 v[164:167], v7, s[80:83], s77 offen
    s_add_u32 s77, s77, 7168
    buffer_load_dwordx4 v[168:171], v7, s[80:83], s77 offen
    s_add_u32 s77, s77, 7168
    buffer_load_dwordx4 v[172:175], v7, s[80:83], s77 offen
    s_add_u32 s77, s77, 7168
    buffer_load_dwordx4 v[176:179], v7, s[80:83], s77 offen
    s_add_u32 s77, s77, 7168
    buffer_load_dwordx4 v[180:183], v7, s[80:83], s77 offen
    s_add_u32 s77, s77, 7168
    buffer_load_dwordx4 v[184:187], v7, s[80:83], s77 offen
    s_add_u32 s77, s77, 7168
    buffer_load_dwordx4 v[188:191], v7, s[80:83], s77 offen
    s_add_u32 s77, s77, 7168
    buffer_load_dwordx4 v[192:195], v7, s[80:83], s77 offen
    s_add_u32 s77, s77, 7168
    buffer_load_dwordx4 v[196:199], v7, s[80:83], s77 offen
    s_add_u32 s77, s77, 7168
    buffer_load_dwordx4 v[200:203], v7, s[80:83], s77 offen
    s_add_u32 s77, s77, 7168
    buffer_load_dwordx4 v[204:207], v7, s[80:83], s77 offen
    s_add_u32 s77, s77, 7168
    buffer_load_dwordx4 v[208:211], v7, s[80:83], s77 offen
    s_add_u32 s77, s77, 7168
    buffer_load_dwordx4 v[212:215], v7, s[80:83], s77 offen
    s_add_u32 s77, s77, 7168
    buffer_load_dwordx4 v[216:219], v85, s[64:67], s78 offen
kb_kernel_nw16:
    s_and_b32 s4, s2, 7
    s_lshr_b32 s5, s2, 3
    s_lshl_b32 s4, s4, 1
    s_lshr_b32 s6, s5, 4
    s_add_u32 s4, s4, s6
    s_lshl_b32 s99, s4, 7
    s_add_u32 s98, s99, 278528
    s_add_u32 s99, s99, 280576
    v_mov_b32 v152, s98
    s_lshl_b32 s4, s4, 7
    s_and_b32 s5, s5, 15
    s_mul_i32 s6, s5, 112
    s_lshl_b32 s9, s6, 1
    s_mul_i32 s13, s5, 100352
    v_lshlrev_b32 v12, 4, v0
    v_lshlrev_b32 v7, 4, v4
    v_lshl_add_u32 v7, v2, 6, v7
    s_lshl_b32 s10, s6, 2
    v_mul_u32_u24 v10, 14336, v2
    v_lshl_add_u32 v10, v1, 4, v10
    s_mul_i32 s76, s7, 14336
    s_mul_i32 s20, s4, 896
    s_add_u32 s56, s52, 15728640
    s_addc_u32 s57, s53, 0
    s_mov_b32 s58, 1835008
    s_mov_b32 s59, 0x00020000
    s_add_u32 s64, s52, 65536
    s_addc_u32 s65, s53, 0
    s_mov_b32 s66, 65536
    s_mov_b32 s67, 0x00020000
    s_add_u32 s72, s52, 17825792
    s_addc_u32 s73, s53, 0
    s_mov_b32 s74, 7340032
    s_mov_b32 s75, 0x00020000
    v_lshrrev_b32 v15, 1, v4
    v_lshlrev_b32 v13, 9, v15
    v_and_b32 v15, 1, v4
    v_lshl_add_u32 v13, v15, 8, v13
    v_lshl_add_u32 v13, v3, 4, v13
    v_add_u32 v14, 57344, v13
    v_mov_b32 v72, 0
    v_mov_b32 v73, 0
    v_mov_b32 v74, 0
    v_mov_b32 v75, 0
    v_mov_b32 v76, 0
    v_mov_b32 v77, 0
    v_mov_b32 v78, 0
    v_mov_b32 v79, 0
    v_mov_b32 v80, 0
    v_mov_b32 v81, 0
    v_mov_b32 v82, 0
    v_mov_b32 v83, 0
    v_mov_b32 v84, 0
    v_mov_b32 v85, 0
    v_mov_b32 v86, 0
    v_mov_b32 v87, 0
    v_mov_b32 v88, 0
    v_mov_b32 v89, 0
    v_mov_b32 v90, 0
    v_mov_b32 v91, 0
    v_mov_b32 v92, 0
    v_mov_b32 v93, 0
    v_mov_b32 v94, 0
    v_mov_b32 v95, 0
    v_mov_b32 v96, 0
    v_mov_b32 v97, 0
    v_mov_b32 v98, 0
    v_mov_b32 v99, 0
    v_mov_b32 v100, 0
    v_mov_b32 v101, 0
    v_mov_b32 v102, 0
    v_mov_b32 v103, 0
    s_cmp_lg_u32 s7, 7
    s_nop 0
    s_cbranch_scc1 kb_kernel_polld18
    s_mov_b64 s[96:97], exec
    s_mov_b64 exec, 1
    s_mov_b32 s98, 0x200000
kb_kernel_poll17:
    buffer_load_dword v250, v152, s[92:95], 0 offen sc1
    s_waitcnt vmcnt(0)
    v_cmp_gt_u32 vcc, 16, v250
    s_sub_u32 s98, s98, 1
    s_cmp_eq_u32 s98, 0
    s_nop 2
    s_cbranch_scc1 kb_kernel_polld18_x
    s_cbranch_vccz kb_kernel_polld18_x
    s_sleep 1
    s_branch kb_kernel_poll17
kb_kernel_polld18_x:
    s_mov_b64 exec, s[96:97]
kb_kernel_polld18:
    s_barrier
    s_cmp_eq_u32 s7, 7
    s_cbranch_scc1 kb_kernel_w719
    s_add_u32 m0, s76, 0
    s_add_u32 s79, s20, 0
    buffer_load_dwordx4 v10, s[56:59], s79 offen sc1 lds
    buffer_load_dwordx4 v10, s[56:59], s79 offen offset:1024 sc1 lds
    s_add_u32 m0, s76, 2048
    s_add_u32 s79, s20, 2048
    buffer_load_dwordx4 v10, s[56:59], s79 offen sc1 lds
    buffer_load_dwordx4 v10, s[56:59], s79 offen offset:1024 sc1 lds
    s_add_u32 m0, s76, 4096
    s_add_u32 s79, s20, 4096
    buffer_load_dwordx4 v10, s[56:59], s79 offen sc1 lds
    buffer_load_dwordx4 v10, s[56:59], s79 offen offset:1024 sc1 lds
    s_add_u32 m0, s76, 6144
    s_add_u32 s79, s20, 6144
    buffer_load_dwordx4 v10, s[56:59], s79 offen sc1 lds
    buffer_load_dwordx4 v10, s[56:59], s79 offen offset:1024 sc1 lds
    s_add_u32 m0, s76, 8192
    s_add_u32 s79, s20, 8192
    buffer_load_dwordx4 v10, s[56:59], s79 offen sc1 lds
    buffer_load_dwordx4 v10, s[56:59], s79 offen offset:1024 sc1 lds
    s_add_u32 m0, s76, 10240
    s_add_u32 s79, s20, 10240
    buffer_load_dwordx4 v10, s[56:59], s79 offen sc1 lds
    buffer_load_dwordx4 v10, s[56:59], s79 offen offset:1024 sc1 lds
    s_add_u32 m0, s76, 12288
    s_add_u32 s79, s20, 12288
    buffer_load_dwordx4 v10, s[56:59], s79 offen sc1 lds
    buffer_load_dwordx4 v10, s[56:59], s79 offen offset:1024 sc1 lds
    s_waitcnt vmcnt(12)
    s_barrier
    ds_read_b128 v[104:107], v13 offset:0
    ds_read_b128 v[108:111], v13 offset:14336
    ds_read_b128 v[112:115], v13 offset:28672
    ds_read_b128 v[116:119], v13 offset:43008
    ds_read_b128 v[120:123], v14 offset:0
    ds_read_b128 v[124:127], v14 offset:14336
    ds_read_b128 v[128:131], v14 offset:28672
    ds_read_b128 v[132:135], v14 offset:43008
    ds_read_b128 v[136:139], v13 offset:1024
    ds_read_b128 v[140:143], v13 offset:15360
    ds_read_b128 v[144:147], v13 offset:29696
    ds_read_b128 v[148:151], v13 offset:44032
    s_waitcnt lgkmcnt(11)
    v_mfma_f32_16x16x32_bf16 v[72:75], v[160:163], v[104:107], v[72:75]
    ds_read_b128 v[104:107], v14 offset:1024
    s_waitcnt lgkmcnt(11)
    v_mfma_f32_16x16x32_bf16 v[76:79], v[160:163], v[108:111], v[76:79]
    ds_read_b128 v[108:111], v14 offset:15360
    s_waitcnt lgkmcnt(11)
    v_mfma_f32_16x16x32_bf16 v[80:83], v[160:163], v[112:115], v[80:83]
    ds_read_b128 v[112:115], v14 offset:29696
    s_waitcnt lgkmcnt(11)
    v_mfma_f32_16x16x32_bf16 v[84:87], v[160:163], v[116:119], v[84:87]
    ds_read_b128 v[116:119], v14 offset:44032
    s_waitcnt lgkmcnt(11)
    v_mfma_f32_16x16x32_bf16 v[88:91], v[160:163], v[120:123], v[88:91]
    s_waitcnt vmcnt(10)
    s_barrier
    ds_read_b128 v[120:123], v13 offset:2048
    s_waitcnt lgkmcnt(11)
    v_mfma_f32_16x16x32_bf16 v[92:95], v[160:163], v[124:127], v[92:95]
    ds_read_b128 v[124:127], v13 offset:16384
    s_waitcnt lgkmcnt(11)
    v_mfma_f32_16x16x32_bf16 v[96:99], v[160:163], v[128:131], v[96:99]
    ds_read_b128 v[128:131], v13 offset:30720
    s_waitcnt lgkmcnt(11)
    v_mfma_f32_16x16x32_bf16 v[100:103], v[160:163], v[132:135], v[100:103]
    ds_read_b128 v[132:135], v13 offset:45056
    s_waitcnt lgkmcnt(11)
    v_mfma_f32_16x16x32_bf16 v[72:75], v[164:167], v[136:139], v[72:75]
    ds_read_b128 v[136:139], v14 offset:2048
    s_waitcnt lgkmcnt(11)
    v_mfma_f32_16x16x32_bf16 v[76:79], v[164:167], v[140:143], v[76:79]
    ds_read_b128 v[140:143], v14 offset:16384
    s_waitcnt lgkmcnt(11)
    v_mfma_f32_16x16x32_bf16 v[80:83], v[164:167], v[144:147], v[80:83]
    ds_read_b128 v[144:147], v14 offset:30720
    s_waitcnt lgkmcnt(11)
    v_mfma_f32_16x16x32_bf16 v[84:87], v[164:167], v[148:151], v[84:87]
    ds_read_b128 v[148:151], v14 offset:45056
    s_waitcnt lgkmcnt(11)
    v_mfma_f32_16x16x32_bf16 v[88:91], v[164:167], v[104:107], v[88:91]
    ds_read_b128 v[104:107], v13 offset:3072
    s_waitcnt lgkmcnt(11)
    v_mfma_f32_16x16x32_bf16 v[92:95], v[164:167], v[108:111], v[92:95]
    ds_read_b128 v[108:111], v13 offset:17408
    s_waitcnt lgkmcnt(11)
    v_mfma_f32_16x16x32_bf16 v[96:99], v[164:167], v[112:115], v[96:99]
    ds_read_b128 v[112:115], v13 offset:31744
    s_waitcnt lgkmcnt(11)
    v_mfma_f32_16x16x32_bf16 v[100:103], v[164:167], v[116:119], v[100:103]
    ds_read_b128 v[116:119], v13 offset:46080
    s_waitcnt lgkmcnt(11)
    v_mfma_f32_16x16x32_bf16 v[72:75], v[168:171], v[120:123], v[72:75]
    ds_read_b128 v[120:123], v14 offset:3072
    s_waitcnt lgkmcnt(11)
    v_mfma_f32_16x16x32_bf16 v[76:79], v[168:171], v[124:127], v[76:79]
    ds_read_b128 v[124:127], v14 offset:17408
    s_waitcnt lgkmcnt(11)
    v_mfma_f32_16x16x32_bf16 v[80:83], v[168:171], v[128:131], v[80:83]
    ds_read_b128 v[128:131], v14 offset:31744
    s_waitcnt lgkmcnt(11)
    v_mfma_f32_16x16x32_bf16 v[84:87], v[168:171], v[132:135], v[84:87]
    ds_read_b128 v[132:135], v14 offset:46080
    s_waitcnt lgkmcnt(11)
    v_mfma_f32_16x16x32_bf16 v[88:91], v[168:171], v[136:139], v[88:91]
    s_waitcnt vmcnt(8)
    s_barrier
    ds_read_b128 v[136:139], v13 offset:4096
    s_waitcnt lgkmcnt(11)
    v_mfma_f32_16x16x32_bf16 v[92:95], v[168:171], v[140:143], v[92:95]
    ds_read_b128 v[140:143], v13 offset:18432
    s_waitcnt lgkmcnt(11)
    v_mfma_f32_16x16x32_bf16 v[96:99], v[168:171], v[144:147], v[96:99]
    ds_read_b128 v[144:147], v13 offset:32768
    s_waitcnt lgkmcnt(11)
    v_mfma_f32_16x16x32_bf16 v[100:103], v[168:171], v[148:151], v[100:103]
    ds_read_b128 v[148:151], v13 offset:47104
    s_waitcnt lgkmcnt(11)
    v_mfma_f32_16x16x32_bf16 v[72:75], v[172:175], v[104:107], v[72:75]
    ds_read_b128 v[104:107], v14 offset:4096
    s_waitcnt lgkmcnt(11)
    v_mfma_f32_16x16x32_bf16 v[76:79], v[172:175], v[108:111], v[76:79]
    ds_read_b128 v[108:111], v14 offset:18432
    s_waitcnt lgkmcnt(11)
    v_mfma_f32_16x16x32_bf16 v[80:83], v[172:175], v[112:115], v[80:83]
    ds_read_b128 v[112:115], v14 offset:32768
    s_waitcnt lgkmcnt(11)
    v_mfma_f32_16x16x32_bf16 v[84:87], v[172:175], v[116:119], v[84:87]
    ds_read_b128 v[116:119], v14 offset:47104
    s_waitcnt lgkmcnt(11)
    v_mfma_f32_16x16x32_bf16 v[88:91], v[172:175], v[120:123], v[88:91]
    ds_read_b128 v[120:123], v13 offset:5120
    s_waitcnt lgkmcnt(11)
    v_mfma_f32_16x16x32_bf16 v[92:95], v[172:175], v[124:127], v[92:95]
    ds_read_b128 v[124:127], v13 offset:19456
    s_waitcnt lgkmcnt(11)
    v_mfma_f32_16x16x32_bf16 v[96:99], v[172:175], v[128:131], v[96:99]
    ds_read_b128 v[128:131], v13 offset:33792
    s_waitcnt lgkmcnt(11)
    v_mfma_f32_16x16x32_bf16 v[100:103], v[172:175], v[132:135], v[100:103]
    ds_read_b128 v[132:135], v13 offset:48128
    s_waitcnt lgkmcnt(11)
    v_mfma_f32_16x16x32_bf16 v[72:75], v[176:179], v[136:139], v[72:75]
    ds_read_b128 v[136:139], v14 offset:5120
    s_waitcnt lgkmcnt(11)
    v_mfma_f32_16x16x32_bf16 v[76:79], v[176:179], v[140:143], v[76:79]
    ds_read_b128 v[140:143], v14 offset:19456
    s_waitcnt lgkmcnt(11)
    v_mfma_f32_16x16x32_bf16 v[80:83], v[176:179], v[144:147], v[80:83]
    ds_read_b128 v[144:147], v14 offset:33792
    s_waitcnt lgkmcnt(11)
    v_mfma_f32_16x16x32_bf16 v[84:87], v[176:179], v[148:151], v[84:87]
    ds_read_b128 v[148:151], v14 offset:48128
    s_waitcnt lgkmcnt(11)
    v_mfma_f32_16x16x32_bf16 v[88:91], v[176:179], v[104:107], v[88:91]
    s_waitcnt vmcnt(4)
    s_barrier
    ds_read_b128 v[104:107], v13 offset:6144
    s_waitcnt lgkmcnt(11)
    v_mfma_f32_16x16x32_bf16 v[92:95], v[176:179], v[108:111], v[92:95]
    ds_read_b128 v[108:111], v13 offset:20480
    s_waitcnt lgkmcnt(11)
    v_mfma_f32_16x16x32_bf16 v[96:99], v[176:179], v[112:115], v[96:99]
    ds_read_b128 v[112:115], v13 offset:34816
    s_waitcnt lgkmcnt(11)
    v_mfma_f32_16x16x32_bf16 v[100:103], v[176:179], v[116:119], v[100:103]
    ds_read_b128 v[116:119], v13 offset:49152
    s_waitcnt lgkmcnt(11)
    v_mfma_f32_16x16x32_bf16 v[72:75], v[180:183], v[120:123], v[72:75]
    ds_read_b128 v[120:123], v14 offset:6144
    s_waitcnt lgkmcnt(11)
    v_mfma_f32_16x16x32_bf16 v[76:79], v[180:183], v[124:127], v[76:79]
    ds_read_b128 v[124:127], v14 offset:20480
    s_waitcnt lgkmcnt(11)
    v_mfma_f32_16x16x32_bf16 v[80:83], v[180:183], v[128:131], v[80:83]
    ds_read_b128 v[128:131], v14 offset:34816
    s_waitcnt lgkmcnt(11)
    v_mfma_f32_16x16x32_bf16 v[84:87], v[180:183], v[132:135], v[84:87]
    ds_read_b128 v[132:135], v14 offset:49152
    s_waitcnt lgkmcnt(11)
    v_mfma_f32_16x16x32_bf16 v[88:91], v[180:183], v[136:139], v[88:91]
    ds_read_b128 v[136:139], v13 offset:7168
    s_waitcnt lgkmcnt(11)
    v_mfma_f32_16x16x32_bf16 v[92:95], v[180:183], v[140:143], v[92:95]
    ds_read_b128 v[140:143], v13 offset:21504
    s_waitcnt lgkmcnt(11)
    v_mfma_f32_16x16x32_bf16 v[96:99], v[180:183], v[144:147], v[96:99]
    ds_read_b128 v[144:147], v13 offset:35840
    s_waitcnt lgkmcnt(11)
    v_mfma_f32_16x16x32_bf16 v[100:103], v[180:183], v[148:151], v[100:103]
    ds_read_b128 v[148:151], v13 offset:50176
    s_waitcnt lgkmcnt(11)
    v_mfma_f32_16x16x32_bf16 v[72:75], v[184:187], v[104:107], v[72:75]
    ds_read_b128 v[104:107], v14 offset:7168
    s_waitcnt lgkmcnt(11)
    v_mfma_f32_16x16x32_bf16 v[76:79], v[184:187], v[108:111], v[76:79]
    ds_read_b128 v[108:111], v14 offset:21504
    s_waitcnt lgkmcnt(11)
    v_mfma_f32_16x16x32_bf16 v[80:83], v[184:187], v[112:115], v[80:83]
    ds_read_b128 v[112:115], v14 offset:35840
    s_waitcnt lgkmcnt(11)
    v_mfma_f32_16x16x32_bf16 v[84:87], v[184:187], v[116:119], v[84:87]
    ds_read_b128 v[116:119], v14 offset:50176
    s_waitcnt lgkmcnt(11)
    v_mfma_f32_16x16x32_bf16 v[88:91], v[184:187], v[120:123], v[88:91]
    ds_read_b128 v[120:123], v13 offset:8192
    s_waitcnt lgkmcnt(11)
    v_mfma_f32_16x16x32_bf16 v[92:95], v[184:187], v[124:127], v[92:95]
    ds_read_b128 v[124:127], v13 offset:22528
    s_waitcnt lgkmcnt(11)
    v_mfma_f32_16x16x32_bf16 v[96:99], v[184:187], v[128:131], v[96:99]
    ds_read_b128 v[128:131], v13 offset:36864
    s_waitcnt lgkmcnt(11)
    v_mfma_f32_16x16x32_bf16 v[100:103], v[184:187], v[132:135], v[100:103]
    ds_read_b128 v[132:135], v13 offset:51200
    s_waitcnt lgkmcnt(11)
    v_mfma_f32_16x16x32_bf16 v[72:75], v[188:191], v[136:139], v[72:75]
    ds_read_b128 v[136:139], v14 offset:8192
    s_waitcnt lgkmcnt(11)
    v_mfma_f32_16x16x32_bf16 v[76:79], v[188:191], v[140:143], v[76:79]
    ds_read_b128 v[140:143], v14 offset:22528
    s_waitcnt lgkmcnt(11)
    v_mfma_f32_16x16x32_bf16 v[80:83], v[188:191], v[144:147], v[80:83]
    ds_read_b128 v[144:147], v14 offset:36864
    s_waitcnt lgkmcnt(11)
    v_mfma_f32_16x16x32_bf16 v[84:87], v[188:191], v[148:151], v[84:87]
    ds_read_b128 v[148:151], v14 offset:51200
    s_waitcnt lgkmcnt(11)
    v_mfma_f32_16x16x32_bf16 v[88:91], v[188:191], v[104:107], v[88:91]
    ds_read_b128 v[104:107], v13 offset:9216
    s_waitcnt lgkmcnt(11)
    v_mfma_f32_16x16x32_bf16 v[92:95], v[188:191], v[108:111], v[92:95]
    ds_read_b128 v[108:111], v13 offset:23552
    s_waitcnt lgkmcnt(11)
    v_mfma_f32_16x16x32_bf16 v[96:99], v[188:191], v[112:115], v[96:99]
    ds_read_b128 v[112:115], v13 offset:37888
    s_waitcnt lgkmcnt(11)
    v_mfma_f32_16x16x32_bf16 v[100:103], v[188:191], v[116:119], v[100:103]
    ds_read_b128 v[116:119], v13 offset:52224
    s_waitcnt lgkmcnt(11)
    v_mfma_f32_16x16x32_bf16 v[72:75], v[192:195], v[120:123], v[72:75]
    ds_read_b128 v[120:123], v14 offset:9216
    s_waitcnt lgkmcnt(11)
    v_mfma_f32_16x16x32_bf16 v[76:79], v[192:195], v[124:127], v[76:79]
    ds_read_b128 v[124:127], v14 offset:23552
    s_waitcnt lgkmcnt(11)
    v_mfma_f32_16x16x32_bf16 v[80:83], v[192:195], v[128:131], v[80:83]
    ds_read_b128 v[128:131], v14 offset:37888
    s_waitcnt lgkmcnt(11)
    v_mfma_f32_16x16x32_bf16 v[84:87], v[192:195], v[132:135], v[84:87]
    ds_read_b128 v[132:135], v14 offset:52224
    s_waitcnt lgkmcnt(11)
    v_mfma_f32_16x16x32_bf16 v[88:91], v[192:195], v[136:139], v[88:91]
    s_waitcnt vmcnt(0)
    s_barrier
    ds_read_b128 v[136:139], v13 offset:10240
    s_waitcnt lgkmcnt(11)
    v_mfma_f32_16x16x32_bf16 v[92:95], v[192:195], v[140:143], v[92:95]
    ds_read_b128 v[140:143], v13 offset:24576
    s_waitcnt lgkmcnt(11)
    v_mfma_f32_16x16x32_bf16 v[96:99], v[192:195], v[144:147], v[96:99]
    ds_read_b128 v[144:147], v13 offset:38912
    s_waitcnt lgkmcnt(11)
    v_mfma_f32_16x16x32_bf16 v[100:103], v[192:195], v[148:151], v[100:103]
    ds_read_b128 v[148:151], v13 offset:53248
    s_waitcnt lgkmcnt(11)
    v_mfma_f32_16x16x32_bf16 v[72:75], v[196:199], v[104:107], v[72:75]
    ds_read_b128 v[104:107], v14 offset:10240
    s_waitcnt lgkmcnt(11)
    v_mfma_f32_16x16x32_bf16 v[76:79], v[196:199], v[108:111], v[76:79]
    ds_read_b128 v[108:111], v14 offset:24576
    s_waitcnt lgkmcnt(11)
    v_mfma_f32_16x16x32_bf16 v[80:83], v[196:199], v[112:115], v[80:83]
    ds_read_b128 v[112:115], v14 offset:38912
    s_waitcnt lgkmcnt(11)
    v_mfma_f32_16x16x32_bf16 v[84:87], v[196:199], v[116:119], v[84:87]
    ds_read_b128 v[116:119], v14 offset:53248
    s_waitcnt lgkmcnt(11)
    v_mfma_f32_16x16x32_bf16 v[88:91], v[196:199], v[120:123], v[88:91]
    ds_read_b128 v[120:123], v13 offset:11264
    s_waitcnt lgkmcnt(11)
    v_mfma_f32_16x16x32_bf16 v[92:95], v[196:199], v[124:127], v[92:95]
    ds_read_b128 v[124:127], v13 offset:25600
    s_waitcnt lgkmcnt(11)
    v_mfma_f32_16x16x32_bf16 v[96:99], v[196:199], v[128:131], v[96:99]
    ds_read_b128 v[128:131], v13 offset:39936
    s_waitcnt lgkmcnt(11)
    v_mfma_f32_16x16x32_bf16 v[100:103], v[196:199], v[132:135], v[100:103]
    ds_read_b128 v[132:135], v13 offset:54272
    s_waitcnt lgkmcnt(11)
    v_mfma_f32_16x16x32_bf16 v[72:75], v[200:203], v[136:139], v[72:75]
    ds_read_b128 v[136:139], v14 offset:11264
    s_waitcnt lgkmcnt(11)
    v_mfma_f32_16x16x32_bf16 v[76:79], v[200:203], v[140:143], v[76:79]
    ds_read_b128 v[140:143], v14 offset:25600
    s_waitcnt lgkmcnt(11)
    v_mfma_f32_16x16x32_bf16 v[80:83], v[200:203], v[144:147], v[80:83]
    ds_read_b128 v[144:147], v14 offset:39936
    s_waitcnt lgkmcnt(11)
    v_mfma_f32_16x16x32_bf16 v[84:87], v[200:203], v[148:151], v[84:87]
    ds_read_b128 v[148:151], v14 offset:54272
    s_waitcnt lgkmcnt(11)
    v_mfma_f32_16x16x32_bf16 v[88:91], v[200:203], v[104:107], v[88:91]
    ds_read_b128 v[104:107], v13 offset:12288
    s_waitcnt lgkmcnt(11)
    v_mfma_f32_16x16x32_bf16 v[92:95], v[200:203], v[108:111], v[92:95]
    ds_read_b128 v[108:111], v13 offset:26624
    s_waitcnt lgkmcnt(11)
    v_mfma_f32_16x16x32_bf16 v[96:99], v[200:203], v[112:115], v[96:99]
    ds_read_b128 v[112:115], v13 offset:40960
    s_waitcnt lgkmcnt(11)
    v_mfma_f32_16x16x32_bf16 v[100:103], v[200:203], v[116:119], v[100:103]
    ds_read_b128 v[116:119], v13 offset:55296
    s_waitcnt lgkmcnt(11)
    v_mfma_f32_16x16x32_bf16 v[72:75], v[204:207], v[120:123], v[72:75]
    ds_read_b128 v[120:123], v14 offset:12288
    s_waitcnt lgkmcnt(11)
    v_mfma_f32_16x16x32_bf16 v[76:79], v[204:207], v[124:127], v[76:79]
    ds_read_b128 v[124:127], v14 offset:26624
    s_waitcnt lgkmcnt(11)
    v_mfma_f32_16x16x32_bf16 v[80:83], v[204:207], v[128:131], v[80:83]
    ds_read_b128 v[128:131], v14 offset:40960
    s_waitcnt lgkmcnt(11)
    v_mfma_f32_16x16x32_bf16 v[84:87], v[204:207], v[132:135], v[84:87]
    ds_read_b128 v[132:135], v14 offset:55296
    s_waitcnt lgkmcnt(11)
    v_mfma_f32_16x16x32_bf16 v[88:91], v[204:207], v[136:139], v[88:91]
    ds_read_b128 v[136:139], v13 offset:13312
    s_waitcnt lgkmcnt(11)
    v_mfma_f32_16x16x32_bf16 v[92:95], v[204:207], v[140:143], v[92:95]
    ds_read_b128 v[140:143], v13 offset:27648
    s_waitcnt lgkmcnt(11)
    v_mfma_f32_16x16x32_bf16 v[96:99], v[204:207], v[144:147], v[96:99]
    ds_read_b128 v[144:147], v13 offset:41984
    s_waitcnt lgkmcnt(11)
    v_mfma_f32_16x16x32_bf16 v[100:103], v[204:207], v[148:151], v[100:103]
    ds_read_b128 v[148:151], v13 offset:56320
    s_waitcnt lgkmcnt(11)
    v_mfma_f32_16x16x32_bf16 v[72:75], v[208:211], v[104:107], v[72:75]
    ds_read_b128 v[104:107], v14 offset:13312
    s_waitcnt lgkmcnt(11)
    v_mfma_f32_16x16x32_bf16 v[76:79], v[208:211], v[108:111], v[76:79]
    ds_read_b128 v[108:111], v14 offset:27648
    s_waitcnt lgkmcnt(11)
    v_mfma_f32_16x16x32_bf16 v[80:83], v[208:211], v[112:115], v[80:83]
    ds_read_b128 v[112:115], v14 offset:41984
    s_waitcnt lgkmcnt(11)
    v_mfma_f32_16x16x32_bf16 v[84:87], v[208:211], v[116:119], v[84:87]
    ds_read_b128 v[116:119], v14 offset:56320
    s_waitcnt lgkmcnt(11)
    v_mfma_f32_16x16x32_bf16 v[88:91], v[208:211], v[120:123], v[88:91]
    s_waitcnt lgkmcnt(10)
    v_mfma_f32_16x16x32_bf16 v[92:95], v[208:211], v[124:127], v[92:95]
    s_waitcnt lgkmcnt(9)
    v_mfma_f32_16x16x32_bf16 v[96:99], v[208:211], v[128:131], v[96:99]
    s_waitcnt lgkmcnt(8)
    v_mfma_f32_16x16x32_bf16 v[100:103], v[208:211], v[132:135], v[100:103]
    s_waitcnt lgkmcnt(7)
    v_mfma_f32_16x16x32_bf16 v[72:75], v[212:215], v[136:139], v[72:75]
    s_waitcnt lgkmcnt(6)
    v_mfma_f32_16x16x32_bf16 v[76:79], v[212:215], v[140:143], v[76:79]
    s_waitcnt lgkmcnt(5)
    v_mfma_f32_16x16x32_bf16 v[80:83], v[212:215], v[144:147], v[80:83]
    s_waitcnt lgkmcnt(4)
    v_mfma_f32_16x16x32_bf16 v[84:87], v[212:215], v[148:151], v[84:87]
    s_waitcnt lgkmcnt(3)
    v_mfma_f32_16x16x32_bf16 v[88:91], v[212:215], v[104:107], v[88:91]
    s_waitcnt lgkmcnt(2)
    v_mfma_f32_16x16x32_bf16 v[92:95], v[212:215], v[108:111], v[92:95]
    s_waitcnt lgkmcnt(1)
    v_mfma_f32_16x16x32_bf16 v[96:99], v[212:215], v[112:115], v[96:99]
    s_waitcnt lgkmcnt(0)
    v_mfma_f32_16x16x32_bf16 v[100:103], v[212:215], v[116:119], v[100:103]
    v_mov_b32 v13, 0xc0135761
    v_mov_b32 v14, 0xbdd2d3e8
    v_and_b32 v15, 1, v4
    v_mul_u32_u24 v15, 57344, v15
    v_lshl_add_u32 v15, v2, 9, v15
    v_lshrrev_b32 v8, 1, v4
    v_lshl_add_u32 v15, v8, 8, v15
    v_lshl_add_u32 v15, v3, 4, v15
    s_mul_i32 s9, s4, 3584
    s_mul_i32 s10, s5, 3584
    s_add_u32 s9, s9, s10
    v_lshlrev_b32 v8, 3, v3
    v_add_u32 v8, 114688, v8
    ds_read_b64 v[16:17], v8 offset:0
    ds_read_b64 v[18:19], v8 offset:128
    ds_read_b64 v[20:21], v8 offset:256
    ds_read_b64 v[22:23], v8 offset:384
    ds_read_b64 v[24:25], v8 offset:512
    ds_read_b64 v[26:27], v8 offset:640
    ds_read_b64 v[28:29], v8 offset:768
    ds_read_b64 v[30:31], v8 offset:896
    s_waitcnt lgkmcnt(0)
    v_fma_f32 v72, -v16, v216, v72
    v_fma_f32 v73, -v16, v217, v73
    v_fma_f32 v74, -v16, v218, v74
    v_fma_f32 v75, -v16, v219, v75
    v_fma_f32 v76, -v18, v216, v76
    v_fma_f32 v77, -v18, v217, v77
    v_fma_f32 v78, -v18, v218, v78
    v_fma_f32 v79, -v18, v219, v79
    v_mul_f32 v72, v72, v17
    v_mul_f32 v73, v73, v17
    v_mul_f32 v74, v74, v17
    v_mul_f32 v75, v75, v17
    v_mul_f32 v76, v76, v19
    v_mul_f32 v77, v77, v19
    v_mul_f32 v78, v78, v19
    v_mul_f32 v79, v79, v19
    v_cvt_pk_bf16_f32 v72, 0, v72
    v_cvt_pk_bf16_f32 v73, 0, v73
    v_cvt_pk_bf16_f32 v74, 0, v74
    v_cvt_pk_bf16_f32 v75, 0, v75
    v_cvt_pk_bf16_f32 v76, 0, v76
    v_cvt_pk_bf16_f32 v77, 0, v77
    v_cvt_pk_bf16_f32 v78, 0, v78
    v_cvt_pk_bf16_f32 v79, 0, v79
    v_mul_f32 v32, v72, v72
    v_mul_f32 v33, v73, v73
    v_mul_f32 v34, v74, v74
    v_mul_f32 v35, v75, v75
    v_mul_f32 v36, v76, v76
    v_mul_f32 v37, v77, v77
    v_mul_f32 v38, v78, v78
    v_mul_f32 v39, v79, v79
    v_fma_f32 v32, v32, v14, v13
    v_fma_f32 v33, v33, v14, v13
    v_fma_f32 v34, v34, v14, v13
    v_fma_f32 v35, v35, v14, v13
    v_fma_f32 v36, v36, v14, v13
    v_fma_f32 v37, v37, v14, v13
    v_fma_f32 v38, v38, v14, v13
    v_fma_f32 v39, v39, v14, v13
    v_mul_f32 v32, v32, v72
    v_mul_f32 v33, v33, v73
    v_mul_f32 v34, v34, v74
    v_mul_f32 v35, v35, v75
    v_mul_f32 v36, v36, v76
    v_mul_f32 v37, v37, v77
    v_mul_f32 v38, v38, v78
    v_mul_f32 v39, v39, v79
    v_exp_f32 v32, v32
    v_exp_f32 v33, v33
    v_exp_f32 v34, v34
    v_exp_f32 v35, v35
    v_exp_f32 v36, v36
    v_exp_f32 v37, v37
    v_exp_f32 v38, v38
    v_exp_f32 v39, v39
    v_add_f32 v32, 1.0, v32
    v_add_f32 v33, 1.0, v33
    v_add_f32 v34, 1.0, v34
    v_add_f32 v35, 1.0, v35
    v_add_f32 v36, 1.0, v36
    v_add_f32 v37, 1.0, v37
    v_add_f32 v38, 1.0, v38
    v_add_f32 v39, 1.0, v39
    v_rcp_f32 v32, v32
    v_rcp_f32 v33, v33
    v_rcp_f32 v34, v34
    v_rcp_f32 v35, v35
    v_rcp_f32 v36, v36
    v_rcp_f32 v37, v37
    v_rcp_f32 v38, v38
    v_rcp_f32 v39, v39
    v_mul_f32 v72, v72, v32
    v_mul_f32 v73, v73, v33
    v_mul_f32 v74, v74, v34
    v_mul_f32 v75, v75, v35
    v_mul_f32 v76, v76, v36
    v_mul_f32 v77, v77, v37
    v_mul_f32 v78, v78, v38
    v_mul_f32 v79, v79, v39
    v_cvt_pk_bf16_f32 v40, v72, v73
    v_cvt_pk_bf16_f32 v41, v74, v75
    v_cvt_pk_bf16_f32 v42, v76, v77
    v_cvt_pk_bf16_f32 v43, v78, v79
    s_nop 0
    v_permlane16_swap_b32 v40, v42
    v_permlane16_swap_b32 v41, v43
    buffer_store_dwordx4 v[40:43], v15, s[72:75], s9 offen sc1
    s_add_u32 s9, s9, 114688
    v_fma_f32 v80, -v20, v216, v80
    v_fma_f32 v81, -v20, v217, v81
    v_fma_f32 v82, -v20, v218, v82
    v_fma_f32 v83, -v20, v219, v83
    v_fma_f32 v84, -v22, v216, v84
    v_fma_f32 v85, -v22, v217, v85
    v_fma_f32 v86, -v22, v218, v86
    v_fma_f32 v87, -v22, v219, v87
    v_mul_f32 v80, v80, v21
    v_mul_f32 v81, v81, v21
    v_mul_f32 v82, v82, v21
    v_mul_f32 v83, v83, v21
    v_mul_f32 v84, v84, v23
    v_mul_f32 v85, v85, v23
    v_mul_f32 v86, v86, v23
    v_mul_f32 v87, v87, v23
    v_cvt_pk_bf16_f32 v80, 0, v80
    v_cvt_pk_bf16_f32 v81, 0, v81
    v_cvt_pk_bf16_f32 v82, 0, v82
    v_cvt_pk_bf16_f32 v83, 0, v83
    v_cvt_pk_bf16_f32 v84, 0, v84
    v_cvt_pk_bf16_f32 v85, 0, v85
    v_cvt_pk_bf16_f32 v86, 0, v86
    v_cvt_pk_bf16_f32 v87, 0, v87
    v_mul_f32 v32, v80, v80
    v_mul_f32 v33, v81, v81
    v_mul_f32 v34, v82, v82
    v_mul_f32 v35, v83, v83
    v_mul_f32 v36, v84, v84
    v_mul_f32 v37, v85, v85
    v_mul_f32 v38, v86, v86
    v_mul_f32 v39, v87, v87
    v_fma_f32 v32, v32, v14, v13
    v_fma_f32 v33, v33, v14, v13
    v_fma_f32 v34, v34, v14, v13
    v_fma_f32 v35, v35, v14, v13
    v_fma_f32 v36, v36, v14, v13
    v_fma_f32 v37, v37, v14, v13
    v_fma_f32 v38, v38, v14, v13
    v_fma_f32 v39, v39, v14, v13
    v_mul_f32 v32, v32, v80
    v_mul_f32 v33, v33, v81
    v_mul_f32 v34, v34, v82
    v_mul_f32 v35, v35, v83
    v_mul_f32 v36, v36, v84
    v_mul_f32 v37, v37, v85
    v_mul_f32 v38, v38, v86
    v_mul_f32 v39, v39, v87
    v_exp_f32 v32, v32
    v_exp_f32 v33, v33
    v_exp_f32 v34, v34
    v_exp_f32 v35, v35
    v_exp_f32 v36, v36
    v_exp_f32 v37, v37
    v_exp_f32 v38, v38
    v_exp_f32 v39, v39
    v_add_f32 v32, 1.0, v32
    v_add_f32 v33, 1.0, v33
    v_add_f32 v34, 1.0, v34
    v_add_f32 v35, 1.0, v35
    v_add_f32 v36, 1.0, v36
    v_add_f32 v37, 1.0, v37
    v_add_f32 v38, 1.0, v38
    v_add_f32 v39, 1.0, v39
    v_rcp_f32 v32, v32
    v_rcp_f32 v33, v33
    v_rcp_f32 v34, v34
    v_rcp_f32 v35, v35
    v_rcp_f32 v36, v36
    v_rcp_f32 v37, v37
    v_rcp_f32 v38, v38
    v_rcp_f32 v39, v39
    v_mul_f32 v80, v80, v32
    v_mul_f32 v81, v81, v33
    v_mul_f32 v82, v82, v34
    v_mul_f32 v83, v83, v35
    v_mul_f32 v84, v84, v36
    v_mul_f32 v85, v85, v37
    v_mul_f32 v86, v86, v38
    v_mul_f32 v87, v87, v39
    v_cvt_pk_bf16_f32 v44, v80, v81
    v_cvt_pk_bf16_f32 v45, v82, v83
    v_cvt_pk_bf16_f32 v46, v84, v85
    v_cvt_pk_bf16_f32 v47, v86, v87
    s_nop 0
    v_permlane16_swap_b32 v44, v46
    v_permlane16_swap_b32 v45, v47
    buffer_store_dwordx4 v[44:47], v15, s[72:75], s9 offen sc1
    s_add_u32 s9, s9, 114688
    v_fma_f32 v88, -v24, v216, v88
    v_fma_f32 v89, -v24, v217, v89
    v_fma_f32 v90, -v24, v218, v90
    v_fma_f32 v91, -v24, v219, v91
    v_fma_f32 v92, -v26, v216, v92
    v_fma_f32 v93, -v26, v217, v93
    v_fma_f32 v94, -v26, v218, v94
    v_fma_f32 v95, -v26, v219, v95
    v_mul_f32 v88, v88, v25
    v_mul_f32 v89, v89, v25
    v_mul_f32 v90, v90, v25
    v_mul_f32 v91, v91, v25
    v_mul_f32 v92, v92, v27
    v_mul_f32 v93, v93, v27
    v_mul_f32 v94, v94, v27
    v_mul_f32 v95, v95, v27
    v_cvt_pk_bf16_f32 v88, 0, v88
    v_cvt_pk_bf16_f32 v89, 0, v89
    v_cvt_pk_bf16_f32 v90, 0, v90
    v_cvt_pk_bf16_f32 v91, 0, v91
    v_cvt_pk_bf16_f32 v92, 0, v92
    v_cvt_pk_bf16_f32 v93, 0, v93
    v_cvt_pk_bf16_f32 v94, 0, v94
    v_cvt_pk_bf16_f32 v95, 0, v95
    v_mul_f32 v32, v88, v88
    v_mul_f32 v33, v89, v89
    v_mul_f32 v34, v90, v90
    v_mul_f32 v35, v91, v91
    v_mul_f32 v36, v92, v92
    v_mul_f32 v37, v93, v93
    v_mul_f32 v38, v94, v94
    v_mul_f32 v39, v95, v95
    v_fma_f32 v32, v32, v14, v13
    v_fma_f32 v33, v33, v14, v13
    v_fma_f32 v34, v34, v14, v13
    v_fma_f32 v35, v35, v14, v13
    v_fma_f32 v36, v36, v14, v13
    v_fma_f32 v37, v37, v14, v13
    v_fma_f32 v38, v38, v14, v13
    v_fma_f32 v39, v39, v14, v13
    v_mul_f32 v32, v32, v88
    v_mul_f32 v33, v33, v89
    v_mul_f32 v34, v34, v90
    v_mul_f32 v35, v35, v91
    v_mul_f32 v36, v36, v92
    v_mul_f32 v37, v37, v93
    v_mul_f32 v38, v38, v94
    v_mul_f32 v39, v39, v95
    v_exp_f32 v32, v32
    v_exp_f32 v33, v33
    v_exp_f32 v34, v34
    v_exp_f32 v35, v35
    v_exp_f32 v36, v36
    v_exp_f32 v37, v37
    v_exp_f32 v38, v38
    v_exp_f32 v39, v39
    v_add_f32 v32, 1.0, v32
    v_add_f32 v33, 1.0, v33
    v_add_f32 v34, 1.0, v34
    v_add_f32 v35, 1.0, v35
    v_add_f32 v36, 1.0, v36
    v_add_f32 v37, 1.0, v37
    v_add_f32 v38, 1.0, v38
    v_add_f32 v39, 1.0, v39
    v_rcp_f32 v32, v32
    v_rcp_f32 v33, v33
    v_rcp_f32 v34, v34
    v_rcp_f32 v35, v35
    v_rcp_f32 v36, v36
    v_rcp_f32 v37, v37
    v_rcp_f32 v38, v38
    v_rcp_f32 v39, v39
    v_mul_f32 v88, v88, v32
    v_mul_f32 v89, v89, v33
    v_mul_f32 v90, v90, v34
    v_mul_f32 v91, v91, v35
    v_mul_f32 v92, v92, v36
    v_mul_f32 v93, v93, v37
    v_mul_f32 v94, v94, v38
    v_mul_f32 v95, v95, v39
    v_cvt_pk_bf16_f32 v40, v88, v89
    v_cvt_pk_bf16_f32 v41, v90, v91
    v_cvt_pk_bf16_f32 v42, v92, v93
    v_cvt_pk_bf16_f32 v43, v94, v95
    s_nop 0
    v_permlane16_swap_b32 v40, v42
    v_permlane16_swap_b32 v41, v43
    buffer_store_dwordx4 v[40:43], v15, s[72:75], s9 offen sc1
    s_add_u32 s9, s9, 114688
    v_fma_f32 v96, -v28, v216, v96
    v_fma_f32 v97, -v28, v217, v97
    v_fma_f32 v98, -v28, v218, v98
    v_fma_f32 v99, -v28, v219, v99
    v_fma_f32 v100, -v30, v216, v100
    v_fma_f32 v101, -v30, v217, v101
    v_fma_f32 v102, -v30, v218, v102
    v_fma_f32 v103, -v30, v219, v103
    v_mul_f32 v96, v96, v29
    v_mul_f32 v97, v97, v29
    v_mul_f32 v98, v98, v29
    v_mul_f32 v99, v99, v29
    v_mul_f32 v100, v100, v31
    v_mul_f32 v101, v101, v31
    v_mul_f32 v102, v102, v31
    v_mul_f32 v103, v103, v31
    v_cvt_pk_bf16_f32 v96, 0, v96
    v_cvt_pk_bf16_f32 v97, 0, v97
    v_cvt_pk_bf16_f32 v98, 0, v98
    v_cvt_pk_bf16_f32 v99, 0, v99
    v_cvt_pk_bf16_f32 v100, 0, v100
    v_cvt_pk_bf16_f32 v101, 0, v101
    v_cvt_pk_bf16_f32 v102, 0, v102
    v_cvt_pk_bf16_f32 v103, 0, v103
    v_mul_f32 v32, v96, v96
    v_mul_f32 v33, v97, v97
    v_mul_f32 v34, v98, v98
    v_mul_f32 v35, v99, v99
    v_mul_f32 v36, v100, v100
    v_mul_f32 v37, v101, v101
    v_mul_f32 v38, v102, v102
    v_mul_f32 v39, v103, v103
    v_fma_f32 v32, v32, v14, v13
    v_fma_f32 v33, v33, v14, v13
    v_fma_f32 v34, v34, v14, v13
    v_fma_f32 v35, v35, v14, v13
    v_fma_f32 v36, v36, v14, v13
    v_fma_f32 v37, v37, v14, v13
    v_fma_f32 v38, v38, v14, v13
    v_fma_f32 v39, v39, v14, v13
    v_mul_f32 v32, v32, v96
    v_mul_f32 v33, v33, v97
    v_mul_f32 v34, v34, v98
    v_mul_f32 v35, v35, v99
    v_mul_f32 v36, v36, v100
    v_mul_f32 v37, v37, v101
    v_mul_f32 v38, v38, v102
    v_mul_f32 v39, v39, v103
    v_exp_f32 v32, v32
    v_exp_f32 v33, v33
    v_exp_f32 v34, v34
    v_exp_f32 v35, v35
    v_exp_f32 v36, v36
    v_exp_f32 v37, v37
    v_exp_f32 v38, v38
    v_exp_f32 v39, v39
    v_add_f32 v32, 1.0, v32
    v_add_f32 v33, 1.0, v33
    v_add_f32 v34, 1.0, v34
    v_add_f32 v35, 1.0, v35
    v_add_f32 v36, 1.0, v36
    v_add_f32 v37, 1.0, v37
    v_add_f32 v38, 1.0, v38
    v_add_f32 v39, 1.0, v39
    v_rcp_f32 v32, v32
    v_rcp_f32 v33, v33
    v_rcp_f32 v34, v34
    v_rcp_f32 v35, v35
    v_rcp_f32 v36, v36
    v_rcp_f32 v37, v37
    v_rcp_f32 v38, v38
    v_rcp_f32 v39, v39
    v_mul_f32 v96, v96, v32
    v_mul_f32 v97, v97, v33
    v_mul_f32 v98, v98, v34
    v_mul_f32 v99, v99, v35
    v_mul_f32 v100, v100, v36
    v_mul_f32 v101, v101, v37
    v_mul_f32 v102, v102, v38
    v_mul_f32 v103, v103, v39
    v_cvt_pk_bf16_f32 v44, v96, v97
    v_cvt_pk_bf16_f32 v45, v98, v99
    v_cvt_pk_bf16_f32 v46, v100, v101
    v_cvt_pk_bf16_f32 v47, v102, v103
    s_nop 0
    v_permlane16_swap_b32 v44, v46
    v_permlane16_swap_b32 v45, v47
    buffer_store_dwordx4 v[44:47], v15, s[72:75], s9 offen sc1
    s_add_u32 s9, s9, 114688
    s_waitcnt vmcnt(0)
    s_branch kb_kernel_j520
kb_kernel_w719:
    v_add_u32 v5, s4, v1
    v_lshlrev_b32 v5, 5, v5
    v_add_u32 v152, 5248, v152
    s_add_u32 m0, s76, 0
    s_add_u32 s79, s20, 0
    buffer_load_dwordx4 v10, s[56:59], s79 offen sc1 lds
    buffer_load_dwordx4 v10, s[56:59], s79 offen offset:1024 sc1 lds
    s_add_u32 m0, s76, 2048
    s_add_u32 s79, s20, 2048
    buffer_load_dwordx4 v10, s[56:59], s79 offen sc1 lds
    buffer_load_dwordx4 v10, s[56:59], s79 offen offset:1024 sc1 lds
    s_add_u32 m0, s76, 4096
    s_add_u32 s79, s20, 4096
    buffer_load_dwordx4 v10, s[56:59], s79 offen sc1 lds
    buffer_load_dwordx4 v10, s[56:59], s79 offen offset:1024 sc1 lds
    s_add_u32 m0, s76, 6144
    s_add_u32 s79, s20, 6144
    buffer_load_dwordx4 v10, s[56:59], s79 offen sc1 lds
    buffer_load_dwordx4 v10, s[56:59], s79 offen offset:1024 sc1 lds
    s_add_u32 m0, s76, 8192
    s_add_u32 s79, s20, 8192
    buffer_load_dwordx4 v10, s[56:59], s79 offen sc1 lds
    buffer_load_dwordx4 v10, s[56:59], s79 offen offset:1024 sc1 lds
    s_add_u32 m0, s76, 10240
    s_add_u32 s79, s20, 10240
    buffer_load_dwordx4 v10, s[56:59], s79 offen sc1 lds
    buffer_load_dwordx4 v10, s[56:59], s79 offen offset:1024 sc1 lds
    s_add_u32 m0, s76, 12288
    s_add_u32 s79, s20, 12288
    buffer_load_dwordx4 v10, s[56:59], s79 offen sc1 lds
    buffer_load_dwordx4 v10, s[56:59], s79 offen offset:1024 sc1 lds
    s_waitcnt vmcnt(12)
    s_barrier
    s_waitcnt vmcnt(10)
    s_barrier
    s_waitcnt vmcnt(8)
    s_barrier
    s_waitcnt vmcnt(4)
    s_barrier
    s_mov_b32 s98, 0x200000
kb_kernel_sp21:
    buffer_load_dword v250, v152, s[92:95], 0 offen sc1
    s_waitcnt vmcnt(0)
    v_readfirstlane_b32 s24, v250
    s_sub_u32 s98, s98, 1
    s_cmp_eq_u32 s98, 0
    s_nop 2
    s_cbranch_scc1 kb_kernel_spd22
    s_cmp_lt_u32 s24, 16
    s_cbranch_scc1 kb_kernel_sp21
kb_kernel_spd22:
    buffer_load_dwordx4 v[16:19], v5, s[64:67], 0 offen offset:0 sc1
    buffer_load_dwordx4 v[20:23], v5, s[64:67], 0 offen offset:16 sc1
    buffer_load_dwordx4 v[24:27], v5, s[64:67], 0 offen offset:2048 sc1
    buffer_load_dwordx4 v[28:31], v5, s[64:67], 0 offen offset:2064 sc1
    s_waitcnt vmcnt(0)
    v_add_f32 v50, v16, v18
    v_add_f32 v51, v20, v22
    v_add_f32 v50, v50, v51
    v_mul_f32 v50, 0.25, v50
    v_add_f32 v51, v17, v19
    v_add_f32 v52, v21, v23
    v_add_f32 v51, v51, v52
    v_sub_f32 v52, v16, v50
    v_mul_f32 v53, v52, v52
    v_sub_f32 v52, v18, v50
    v_fmac_f32 v53, v52, v52
    v_sub_f32 v52, v20, v50
    v_fmac_f32 v53, v52, v52
    v_sub_f32 v52, v22, v50
    v_fmac_f32 v53, v52, v52
    v_fmac_f32 v51, 0x42e00000, v53
    v_mul_f32 v51, 0x3b124925, v51
    v_cvt_pk_bf16_f32 v51, 0, v51
    v_add_f32 v51, 0x3727c5ac, v51
    v_cvt_pk_bf16_f32 v51, 0, v51
    v_sqrt_f32 v51, v51
    s_nop 0
    v_cvt_pk_bf16_f32 v51, 0, v51
    v_rcp_f32 v51, v51
    v_cvt_pk_bf16_f32 v50, 0, v50
    v_lshlrev_b32 v6, 3, v1
    v_add_u32 v6, 114688, v6
    ds_write_b64 v6, v[50:51] offset:0
    v_add_f32 v50, v24, v26
    v_add_f32 v51, v28, v30
    v_add_f32 v50, v50, v51
    v_mul_f32 v50, 0.25, v50
    v_add_f32 v51, v25, v27
    v_add_f32 v52, v29, v31
    v_add_f32 v51, v51, v52
    v_sub_f32 v52, v24, v50
    v_mul_f32 v53, v52, v52
    v_sub_f32 v52, v26, v50
    v_fmac_f32 v53, v52, v52
    v_sub_f32 v52, v28, v50
    v_fmac_f32 v53, v52, v52
    v_sub_f32 v52, v30, v50
    v_fmac_f32 v53, v52, v52
    v_fmac_f32 v51, 0x42e00000, v53
    v_mul_f32 v51, 0x3b124925, v51
    v_cvt_pk_bf16_f32 v51, 0, v51
    v_add_f32 v51, 0x3727c5ac, v51
    v_cvt_pk_bf16_f32 v51, 0, v51
    v_sqrt_f32 v51, v51
    s_nop 0
    v_cvt_pk_bf16_f32 v51, 0, v51
    v_rcp_f32 v51, v51
    v_cvt_pk_bf16_f32 v50, 0, v50
    v_lshlrev_b32 v6, 3, v1
    v_add_u32 v6, 114688, v6
    ds_write_b64 v6, v[50:51] offset:512
    s_waitcnt lgkmcnt(0)
    s_barrier
kb_kernel_j520:
    s_waitcnt lgkmcnt(0)
    s_barrier
    s_cmp_lg_u32 s7, 0
    s_cbranch_scc1 kb_kernel_arr23
    v_mov_b32 v250, 1
    v_mov_b32 v251, 0
    s_mov_b64 s[96:97], exec
    s_mov_b64 exec, 1
    buffer_atomic_add v250, v251, s[92:95], s99 offen sc1
    s_mov_b64 exec, s[96:97]
kb_kernel_arr23:
    s_cmp_eq_u32 s7, 7
    s_cbranch_scc1 kb_kernel_nw24
    s_add_u32 s80, s52, 29360128
    s_addc_u32 s81, s53, 0
    s_mov_b32 s82, 1605632
    s_mov_b32 s83, 0x00020000
    s_lshr_b32 s77, s2, 3
    s_and_b32 s77, s77, 3
    s_mul_i32 s77, s77, 401408
    buffer_load_dwordx4 v[104:107], v12, s[80:83], s77 offen
    s_add_u32 s77, s77, 7168
    buffer_load_dwordx4 v[108:111], v12, s[80:83], s77 offen
    s_add_u32 s77, s77, 7168
    buffer_load_dwordx4 v[112:115], v12, s[80:83], s77 offen
    s_add_u32 s77, s77, 7168
    buffer_load_dwordx4 v[116:119], v12, s[80:83], s77 offen
    s_add_u32 s77, s77, 7168
    buffer_load_dwordx4 v[120:123], v12, s[80:83], s77 offen
    s_add_u32 s77, s77, 7168
    buffer_load_dwordx4 v[124:127], v12, s[80:83], s77 offen
    s_add_u32 s77, s77, 7168
    buffer_load_dwordx4 v[128:131], v12, s[80:83], s77 offen
    s_add_u32 s77, s77, 7168
    buffer_load_dwordx4 v[132:135], v12, s[80:83], s77 offen
    s_add_u32 s77, s77, 7168
    buffer_load_dwordx4 v[136:139], v12, s[80:83], s77 offen
    s_add_u32 s77, s77, 7168
    buffer_load_dwordx4 v[140:143], v12, s[80:83], s77 offen
    s_add_u32 s77, s77, 7168
    buffer_load_dwordx4 v[144:147], v12, s[80:83], s77 offen
    s_add_u32 s77, s77, 7168
    buffer_load_dwordx4 v[148:151], v12, s[80:83], s77 offen
    s_add_u32 s77, s77, 7168
    buffer_load_dwordx4 v[152:155], v12, s[80:83], s77 offen
    s_add_u32 s77, s77, 7168
    buffer_load_dwordx4 v[156:159], v12, s[80:83], s77 offen
    s_add_u32 s77, s77, 7168
    buffer_load_dwordx4 v[160:163], v12, s[80:83], s77 offen
    s_add_u32 s77, s77, 7168
    buffer_load_dwordx4 v[164:167], v12, s[80:83], s77 offen
    s_add_u32 s77, s77, 7168
kb_kernel_nw24:
    s_and_b32 s4, s2, 7
    s_lshr_b32 s5, s2, 3
    s_lshl_b32 s4, s4, 3
    s_lshr_b32 s6, s5, 2
    s_add_u32 s4, s4, s6
    s_lshl_b32 s4, s4, 5
    s_and_b32 s5, s5, 3
    s_mul_i32 s6, s5, 112
    s_lshl_b32 s9, s6, 1
    s_lshr_b32 s98, s4, 7
    s_lshl_b32 s98, s98, 7
    s_add_u32 s98, s98, 280576
    v_mov_b32 v9, s98
    v_lshlrev_b32 v11, 4, v0
    s_mul_i32 s13, s5, 401408
    s_add_u32 s13, s13, 114688
    s_add_u32 s60, s52, 29360128
    s_addc_u32 s61, s53, 0
    s_mov_b32 s62, 1605632
    s_mov_b32 s63, 0x00020000
    s_lshr_b32 s76, s7, 2
    s_mul_i32 s76, s76, 57344
    s_and_b32 s20, s7, 3
    s_lshl_b32 s20, s20, 10
    s_add_u32 s76, s76, s20
    v_lshlrev_b32 v10, 4, v1
    s_mul_i32 s20, s4, 3584
    s_add_u32 s20, s20, s76
    v_lshlrev_b32 v14, 9, v2
    v_lshrrev_b32 v5, 1, v4
    v_lshl_add_u32 v14, v5, 8, v14
    v_lshl_add_u32 v14, v3, 4, v14
    v_and_b32 v5, 1, v4
    v_lshl_add_u32 v14, v5, 3, v14
    s_mul_i32 s77, s4, 896
    s_mul_i32 s78, s5, 3584
    s_add_u32 s77, s77, s78
    s_add_u32 s78, s77, 14336
    v_add_u32 v15, s4, v3
    v_mul_u32_u24 v15, 896, v15
    v_lshl_add_u32 v15, v4, 3, v15
    v_lshl_add_u32 v15, v2, 5, v15
    v_lshlrev_b32 v7, 4, v4
    v_lshl_add_u32 v7, v2, 6, v7
    s_lshl_b32 s12, s6, 2
    s_add_u32 s12, s12, 8960
    s_add_u32 s10, s9, 14336
    s_add_u32 s56, s52, 17825792
    s_addc_u32 s57, s53, 0
    s_mov_b32 s58, 7340032
    s_mov_b32 s59, 0x00020000
    s_add_u32 s64, s52, 15728640
    s_addc_u32 s65, s53, 0
    s_mov_b32 s66, 1835008
    s_mov_b32 s67, 0x00020000
    s_add_u32 s68, s52, 9437184
    s_addc_u32 s69, s53, 0
    s_mov_b32 s70, 1835008
    s_mov_b32 s71, 0x00020000
    s_mov_b32 s72, s52
    s_mov_b32 s73, s53
    s_mov_b32 s74, 10752
    s_mov_b32 s75, 0x00020000
    s_mov_b32 s84, s48
    s_mov_b32 s85, s49
    s_mov_b32 s86, 1835008
    s_mov_b32 s87, 0x00020000
    v_lshrrev_b32 v5, 1, v4
    v_lshlrev_b32 v24, 9, v5
    v_and_b32 v5, 1, v4
    v_lshl_add_u32 v24, v5, 8, v24
    v_lshl_add_u32 v24, v3, 4, v24
    v_add_u32 v25, 57344, v24
    v_mov_b32 v32, 0
    v_mov_b32 v33, 0
    v_mov_b32 v34, 0
    v_mov_b32 v35, 0
    v_mov_b32 v36, 0
    v_mov_b32 v37, 0
    v_mov_b32 v38, 0
    v_mov_b32 v39, 0
    s_cmp_lg_u32 s7, 7
    s_nop 0
    s_cbranch_scc1 kb_kernel_polld26
    s_mov_b64 s[96:97], exec
    s_mov_b64 exec, 1
    s_mov_b32 s98, 0x200000
kb_kernel_poll25:
    buffer_load_dword v250, v9, s[92:95], 0 offen sc1
    s_waitcnt vmcnt(0)
    v_cmp_gt_u32 vcc, 16, v250
    s_sub_u32 s98, s98, 1
    s_cmp_eq_u32 s98, 0
    s_nop 2
    s_cbranch_scc1 kb_kernel_polld26_x
    s_cbranch_vccz kb_kernel_polld26_x
    s_sleep 1
    s_branch kb_kernel_poll25
kb_kernel_polld26_x:
    s_mov_b64 exec, s[96:97]
kb_kernel_polld26:
    s_barrier
    s_cmp_eq_u32 s7, 7
    s_cbranch_scc1 kb_kernel_w727
    s_add_u32 m0, s76, 0
    s_add_u32 s15, s20, 0
    buffer_load_dwordx4 v10, s[56:59], s15 offen sc1 lds
    s_add_u32 m0, s76, 4096
    s_add_u32 s15, s20, 4096
    buffer_load_dwordx4 v10, s[56:59], s15 offen sc1 lds
    s_add_u32 m0, s76, 8192
    s_add_u32 s15, s20, 8192
    buffer_load_dwordx4 v10, s[56:59], s15 offen sc1 lds
    s_add_u32 m0, s76, 12288
    s_add_u32 s15, s20, 12288
    buffer_load_dwordx4 v10, s[56:59], s15 offen sc1 lds
    s_add_u32 m0, s76, 16384
    s_add_u32 s15, s20, 16384
    buffer_load_dwordx4 v10, s[56:59], s15 offen sc1 lds
    s_add_u32 m0, s76, 20480
    s_add_u32 s15, s20, 20480
    buffer_load_dwordx4 v10, s[56:59], s15 offen sc1 lds
    s_waitcnt vmcnt(5)
    s_barrier
    ds_read_b128 v[40:43], v24 offset:0
    ds_read_b128 v[44:47], v25 offset:0
    ds_read_b128 v[48:51], v24 offset:1024
    ds_read_b128 v[52:55], v25 offset:1024
    ds_read_b128 v[56:59], v24 offset:2048
    ds_read_b128 v[60:63], v25 offset:2048
    ds_read_b128 v[64:67], v24 offset:3072
    ds_read_b128 v[68:71], v25 offset:3072
    s_waitcnt vmcnt(4)
    s_barrier
    ds_read_b128 v[72:75], v24 offset:4096
    ds_read_b128 v[76:79], v25 offset:4096
    ds_read_b128 v[80:83], v24 offset:5120
    ds_read_b128 v[84:87], v25 offset:5120
    s_waitcnt lgkmcnt(11)
    v_mfma_f32_16x16x32_bf16 v[32:35], v[104:107], v[40:43], v[32:35]
    ds_read_b128 v[40:43], v24 offset:6144
    s_waitcnt lgkmcnt(11)
    v_mfma_f32_16x16x32_bf16 v[36:39], v[104:107], v[44:47], v[36:39]
    s_add_u32 m0, s76, 24576
    s_add_u32 s15, s20, 24576
    buffer_load_dwordx4 v10, s[56:59], s15 offen sc1 lds
    ds_read_b128 v[44:47], v25 offset:6144
    buffer_load_dwordx4 v[168:171], v11, s[60:63], s13 offen
    s_add_u32 s13, s13, 7168
    s_waitcnt lgkmcnt(11)
    v_mfma_f32_16x16x32_bf16 v[32:35], v[108:111], v[48:51], v[32:35]
    ds_read_b128 v[48:51], v24 offset:7168
    s_waitcnt lgkmcnt(11)
    v_mfma_f32_16x16x32_bf16 v[36:39], v[108:111], v[52:55], v[36:39]
    ds_read_b128 v[52:55], v25 offset:7168
    buffer_load_dwordx4 v[172:175], v11, s[60:63], s13 offen
    s_add_u32 s13, s13, 7168
    s_waitcnt lgkmcnt(11)
    v_mfma_f32_16x16x32_bf16 v[32:35], v[112:115], v[56:59], v[32:35]
    s_waitcnt vmcnt(5)
    s_barrier
    ds_read_b128 v[56:59], v24 offset:8192
    s_waitcnt lgkmcnt(11)
    v_mfma_f32_16x16x32_bf16 v[36:39], v[112:115], v[60:63], v[36:39]
    ds_read_b128 v[60:63], v25 offset:8192
    buffer_load_dwordx4 v[176:179], v11, s[60:63], s13 offen
    s_add_u32 s13, s13, 7168
    s_waitcnt lgkmcnt(11)
    v_mfma_f32_16x16x32_bf16 v[32:35], v[116:119], v[64:67], v[32:35]
    ds_read_b128 v[64:67], v24 offset:9216
    s_waitcnt lgkmcnt(11)
    v_mfma_f32_16x16x32_bf16 v[36:39], v[116:119], v[68:71], v[36:39]
    s_add_u32 m0, s76, 28672
    s_add_u32 s15, s20, 28672
    buffer_load_dwordx4 v10, s[56:59], s15 offen sc1 lds
    ds_read_b128 v[68:71], v25 offset:9216
    buffer_load_dwordx4 v[180:183], v11, s[60:63], s13 offen
    s_add_u32 s13, s13, 7168
    s_waitcnt lgkmcnt(11)
    v_mfma_f32_16x16x32_bf16 v[32:35], v[120:123], v[72:75], v[32:35]
    ds_read_b128 v[72:75], v24 offset:10240
    s_waitcnt lgkmcnt(11)
    v_mfma_f32_16x16x32_bf16 v[36:39], v[120:123], v[76:79], v[36:39]
    ds_read_b128 v[76:79], v25 offset:10240
    buffer_load_dwordx4 v[104:107], v11, s[60:63], s13 offen
    s_add_u32 s13, s13, 7168
    s_waitcnt lgkmcnt(11)
    v_mfma_f32_16x16x32_bf16 v[32:35], v[124:127], v[80:83], v[32:35]
    ds_read_b128 v[80:83], v24 offset:11264
    s_waitcnt lgkmcnt(11)
    v_mfma_f32_16x16x32_bf16 v[36:39], v[124:127], v[84:87], v[36:39]
    ds_read_b128 v[84:87], v25 offset:11264
    buffer_load_dwordx4 v[108:111], v11, s[60:63], s13 offen
    s_add_u32 s13, s13, 7168
    s_waitcnt lgkmcnt(11)
    v_mfma_f32_16x16x32_bf16 v[32:35], v[128:131], v[40:43], v[32:35]
    ds_read_b128 v[40:43], v24 offset:12288
    s_waitcnt lgkmcnt(11)
    v_mfma_f32_16x16x32_bf16 v[36:39], v[128:131], v[44:47], v[36:39]
    s_add_u32 m0, s76, 32768
    s_add_u32 s15, s20, 32768
    buffer_load_dwordx4 v10, s[56:59], s15 offen sc1 lds
    ds_read_b128 v[44:47], v25 offset:12288
    buffer_load_dwordx4 v[112:115], v11, s[60:63], s13 offen
    s_add_u32 s13, s13, 7168
    s_waitcnt lgkmcnt(11)
    v_mfma_f32_16x16x32_bf16 v[32:35], v[132:135], v[48:51], v[32:35]
    ds_read_b128 v[48:51], v24 offset:13312
    s_waitcnt lgkmcnt(11)
    v_mfma_f32_16x16x32_bf16 v[36:39], v[132:135], v[52:55], v[36:39]
    ds_read_b128 v[52:55], v25 offset:13312
    buffer_load_dwordx4 v[116:119], v11, s[60:63], s13 offen
    s_add_u32 s13, s13, 7168
    s_waitcnt lgkmcnt(11)
    v_mfma_f32_16x16x32_bf16 v[32:35], v[136:139], v[56:59], v[32:35]
    ds_read_b128 v[56:59], v24 offset:14336
    s_waitcnt lgkmcnt(11)
    v_mfma_f32_16x16x32_bf16 v[36:39], v[136:139], v[60:63], v[36:39]
    ds_read_b128 v[60:63], v25 offset:14336
    buffer_load_dwordx4 v[120:123], v11, s[60:63], s13 offen
    s_add_u32 s13, s13, 7168
    s_waitcnt lgkmcnt(11)
    v_mfma_f32_16x16x32_bf16 v[32:35], v[140:143], v[64:67], v[32:35]
    ds_read_b128 v[64:67], v24 offset:15360
    s_waitcnt lgkmcnt(11)
    v_mfma_f32_16x16x32_bf16 v[36:39], v[140:143], v[68:71], v[36:39]
    s_add_u32 m0, s76, 36864
    s_add_u32 s15, s20, 36864
    buffer_load_dwordx4 v10, s[56:59], s15 offen sc1 lds
    ds_read_b128 v[68:71], v25 offset:15360
    buffer_load_dwordx4 v[124:127], v11, s[60:63], s13 offen
    s_add_u32 s13, s13, 7168
    s_waitcnt lgkmcnt(11)
    v_mfma_f32_16x16x32_bf16 v[32:35], v[144:147], v[72:75], v[32:35]
    s_waitcnt vmcnt(14)
    s_barrier
    ds_read_b128 v[72:75], v24 offset:16384
    s_waitcnt lgkmcnt(11)
    v_mfma_f32_16x16x32_bf16 v[36:39], v[144:147], v[76:79], v[36:39]
    ds_read_b128 v[76:79], v25 offset:16384
    buffer_load_dwordx4 v[128:131], v11, s[60:63], s13 offen
    s_add_u32 s13, s13, 7168
    s_waitcnt lgkmcnt(11)
    v_mfma_f32_16x16x32_bf16 v[32:35], v[148:151], v[80:83], v[32:35]
    ds_read_b128 v[80:83], v24 offset:17408
    s_waitcnt lgkmcnt(11)
    v_mfma_f32_16x16x32_bf16 v[36:39], v[148:151], v[84:87], v[36:39]
    ds_read_b128 v[84:87], v25 offset:17408
    buffer_load_dwordx4 v[132:135], v11, s[60:63], s13 offen
    s_add_u32 s13, s13, 7168
    s_waitcnt lgkmcnt(11)
    v_mfma_f32_16x16x32_bf16 v[32:35], v[152:155], v[40:43], v[32:35]
    ds_read_b128 v[40:43], v24 offset:18432
    s_waitcnt lgkmcnt(11)
    v_mfma_f32_16x16x32_bf16 v[36:39], v[152:155], v[44:47], v[36:39]
    s_add_u32 m0, s76, 40960
    s_add_u32 s15, s20, 40960
    buffer_load_dwordx4 v10, s[56:59], s15 offen sc1 lds
    ds_read_b128 v[44:47], v25 offset:18432
    buffer_load_dwordx4 v[136:139], v11, s[60:63], s13 offen
    s_add_u32 s13, s13, 7168
    s_waitcnt lgkmcnt(11)
    v_mfma_f32_16x16x32_bf16 v[32:35], v[156:159], v[48:51], v[32:35]
    ds_read_b128 v[48:51], v24 offset:19456
    s_waitcnt lgkmcnt(11)
    v_mfma_f32_16x16x32_bf16 v[36:39], v[156:159], v[52:55], v[36:39]
    ds_read_b128 v[52:55], v25 offset:19456
    buffer_load_dwordx4 v[140:143], v11, s[60:63], s13 offen
    s_add_u32 s13, s13, 7168
    s_waitcnt lgkmcnt(11)
    v_mfma_f32_16x16x32_bf16 v[32:35], v[160:163], v[56:59], v[32:35]
    ds_read_b128 v[56:59], v24 offset:20480
    s_waitcnt lgkmcnt(11)
    v_mfma_f32_16x16x32_bf16 v[36:39], v[160:163], v[60:63], v[36:39]
    ds_read_b128 v[60:63], v25 offset:20480
    buffer_load_dwordx4 v[144:147], v11, s[60:63], s13 offen
    s_add_u32 s13, s13, 7168
    s_waitcnt lgkmcnt(11)
    v_mfma_f32_16x16x32_bf16 v[32:35], v[164:167], v[64:67], v[32:35]
    ds_read_b128 v[64:67], v24 offset:21504
    s_waitcnt lgkmcnt(11)
    v_mfma_f32_16x16x32_bf16 v[36:39], v[164:167], v[68:71], v[36:39]
    s_add_u32 m0, s76, 45056
    s_add_u32 s15, s20, 45056
    buffer_load_dwordx4 v10, s[56:59], s15 offen sc1 lds
    ds_read_b128 v[68:71], v25 offset:21504
    buffer_load_dwordx4 v[148:151], v11, s[60:63], s13 offen
    s_add_u32 s13, s13, 7168
    s_waitcnt vmcnt(20) lgkmcnt(11)
    v_mfma_f32_16x16x32_bf16 v[32:35], v[168:171], v[72:75], v[32:35]
    ds_read_b128 v[72:75], v24 offset:22528
    s_waitcnt lgkmcnt(11)
    v_mfma_f32_16x16x32_bf16 v[36:39], v[168:171], v[76:79], v[36:39]
    ds_read_b128 v[76:79], v25 offset:22528
    buffer_load_dwordx4 v[152:155], v11, s[60:63], s13 offen
    s_add_u32 s13, s13, 7168
    s_waitcnt vmcnt(20) lgkmcnt(11)
    v_mfma_f32_16x16x32_bf16 v[32:35], v[172:175], v[80:83], v[32:35]
    ds_read_b128 v[80:83], v24 offset:23552
    s_waitcnt lgkmcnt(11)
    v_mfma_f32_16x16x32_bf16 v[36:39], v[172:175], v[84:87], v[36:39]
    ds_read_b128 v[84:87], v25 offset:23552
    buffer_load_dwordx4 v[156:159], v11, s[60:63], s13 offen
    s_add_u32 s13, s13, 7168
    s_waitcnt vmcnt(20) lgkmcnt(11)
    v_mfma_f32_16x16x32_bf16 v[32:35], v[176:179], v[40:43], v[32:35]
    s_waitcnt vmcnt(19)
    s_barrier
    ds_read_b128 v[40:43], v24 offset:24576
    s_waitcnt lgkmcnt(11)
    v_mfma_f32_16x16x32_bf16 v[36:39], v[176:179], v[44:47], v[36:39]
    s_add_u32 m0, s76, 49152
    s_add_u32 s15, s20, 49152
    buffer_load_dwordx4 v10, s[56:59], s15 offen sc1 lds
    ds_read_b128 v[44:47], v25 offset:24576
    buffer_load_dwordx4 v[160:163], v11, s[60:63], s13 offen
    s_add_u32 s13, s13, 7168
    s_waitcnt vmcnt(20) lgkmcnt(11)
    v_mfma_f32_16x16x32_bf16 v[32:35], v[180:183], v[48:51], v[32:35]
    ds_read_b128 v[48:51], v24 offset:25600
    s_waitcnt lgkmcnt(11)
    v_mfma_f32_16x16x32_bf16 v[36:39], v[180:183], v[52:55], v[36:39]
    ds_read_b128 v[52:55], v25 offset:25600
    buffer_load_dwordx4 v[164:167], v11, s[60:63], s13 offen
    s_add_u32 s13, s13, 7168
    s_waitcnt vmcnt(20) lgkmcnt(11)
    v_mfma_f32_16x16x32_bf16 v[32:35], v[104:107], v[56:59], v[32:35]
    ds_read_b128 v[56:59], v24 offset:26624
    s_waitcnt lgkmcnt(11)
    v_mfma_f32_16x16x32_bf16 v[36:39], v[104:107], v[60:63], v[36:39]
    ds_read_b128 v[60:63], v25 offset:26624
    buffer_load_dwordx4 v[168:171], v11, s[60:63], s13 offen
    s_add_u32 s13, s13, 7168
    s_waitcnt vmcnt(20) lgkmcnt(11)
    v_mfma_f32_16x16x32_bf16 v[32:35], v[108:111], v[64:67], v[32:35]
    ds_read_b128 v[64:67], v24 offset:27648
    s_waitcnt lgkmcnt(11)
    v_mfma_f32_16x16x32_bf16 v[36:39], v[108:111], v[68:71], v[36:39]
    s_add_u32 m0, s76, 53248
    s_add_u32 s15, s20, 53248
    buffer_load_dwordx4 v10, s[56:59], s15 offen sc1 lds
    ds_read_b128 v[68:71], v25 offset:27648
    buffer_load_dwordx4 v[172:175], v11, s[60:63], s13 offen
    s_add_u32 s13, s13, 7168
    s_waitcnt vmcnt(20) lgkmcnt(11)
    v_mfma_f32_16x16x32_bf16 v[32:35], v[112:115], v[72:75], v[32:35]
    ds_read_b128 v[72:75], v24 offset:28672
    s_waitcnt lgkmcnt(11)
    v_mfma_f32_16x16x32_bf16 v[36:39], v[112:115], v[76:79], v[36:39]
    ds_read_b128 v[76:79], v25 offset:28672
    buffer_load_dwordx4 v[176:179], v11, s[60:63], s13 offen
    s_add_u32 s13, s13, 7168
    s_waitcnt vmcnt(20) lgkmcnt(11)
    v_mfma_f32_16x16x32_bf16 v[32:35], v[116:119], v[80:83], v[32:35]
    ds_read_b128 v[80:83], v24 offset:29696
    s_waitcnt lgkmcnt(11)
    v_mfma_f32_16x16x32_bf16 v[36:39], v[116:119], v[84:87], v[36:39]
    ds_read_b128 v[84:87], v25 offset:29696
    buffer_load_dwordx4 v[180:183], v11, s[60:63], s13 offen
    s_add_u32 s13, s13, 7168
    s_waitcnt vmcnt(20) lgkmcnt(11)
    v_mfma_f32_16x16x32_bf16 v[32:35], v[120:123], v[40:43], v[32:35]
    ds_read_b128 v[40:43], v24 offset:30720
    s_waitcnt lgkmcnt(11)
    v_mfma_f32_16x16x32_bf16 v[36:39], v[120:123], v[44:47], v[36:39]
    ds_read_b128 v[44:47], v25 offset:30720
    buffer_load_dwordx4 v[104:107], v11, s[60:63], s13 offen
    s_add_u32 s13, s13, 7168
    s_waitcnt vmcnt(19) lgkmcnt(11)
    v_mfma_f32_16x16x32_bf16 v[32:35], v[124:127], v[48:51], v[32:35]
    ds_read_b128 v[48:51], v24 offset:31744
    s_waitcnt lgkmcnt(11)
    v_mfma_f32_16x16x32_bf16 v[36:39], v[124:127], v[52:55], v[36:39]
    ds_read_b128 v[52:55], v25 offset:31744
    buffer_load_dwordx4 v[108:111], v11, s[60:63], s13 offen
    s_add_u32 s13, s13, 7168
    s_waitcnt vmcnt(19) lgkmcnt(11)
    v_mfma_f32_16x16x32_bf16 v[32:35], v[128:131], v[56:59], v[32:35]
    s_waitcnt vmcnt(21)
    s_barrier
    ds_read_b128 v[56:59], v24 offset:32768
    s_waitcnt lgkmcnt(11)
    v_mfma_f32_16x16x32_bf16 v[36:39], v[128:131], v[60:63], v[36:39]
    ds_read_b128 v[60:63], v25 offset:32768
    buffer_load_dwordx4 v[112:115], v11, s[60:63], s13 offen
    s_add_u32 s13, s13, 7168
    s_waitcnt vmcnt(19) lgkmcnt(11)
    v_mfma_f32_16x16x32_bf16 v[32:35], v[132:135], v[64:67], v[32:35]
    ds_read_b128 v[64:67], v24 offset:33792
    s_waitcnt lgkmcnt(11)
    v_mfma_f32_16x16x32_bf16 v[36:39], v[132:135], v[68:71], v[36:39]
    ds_read_b128 v[68:71], v25 offset:33792
    buffer_load_dwordx4 v[116:119], v11, s[60:63], s13 offen
    s_add_u32 s13, s13, 7168
    s_waitcnt vmcnt(18) lgkmcnt(11)
    v_mfma_f32_16x16x32_bf16 v[32:35], v[136:139], v[72:75], v[32:35]
    ds_read_b128 v[72:75], v24 offset:34816
    s_waitcnt lgkmcnt(11)
    v_mfma_f32_16x16x32_bf16 v[36:39], v[136:139], v[76:79], v[36:39]
    ds_read_b128 v[76:79], v25 offset:34816
    buffer_load_dwordx4 v[120:123], v11, s[60:63], s13 offen
    s_add_u32 s13, s13, 7168
    s_waitcnt vmcnt(18) lgkmcnt(11)
    v_mfma_f32_16x16x32_bf16 v[32:35], v[140:143], v[80:83], v[32:35]
    ds_read_b128 v[80:83], v24 offset:35840
    s_waitcnt lgkmcnt(11)
    v_mfma_f32_16x16x32_bf16 v[36:39], v[140:143], v[84:87], v[36:39]
    ds_read_b128 v[84:87], v25 offset:35840
    buffer_load_dwordx4 v[124:127], v11, s[60:63], s13 offen
    s_add_u32 s13, s13, 7168
    s_waitcnt vmcnt(18) lgkmcnt(11)
    v_mfma_f32_16x16x32_bf16 v[32:35], v[144:147], v[40:43], v[32:35]
    ds_read_b128 v[40:43], v24 offset:36864
    s_waitcnt lgkmcnt(11)
    v_mfma_f32_16x16x32_bf16 v[36:39], v[144:147], v[44:47], v[36:39]
    ds_read_b128 v[44:47], v25 offset:36864
    buffer_load_dwordx4 v[128:131], v11, s[60:63], s13 offen
    s_add_u32 s13, s13, 7168
    s_waitcnt vmcnt(17) lgkmcnt(11)
    v_mfma_f32_16x16x32_bf16 v[32:35], v[148:151], v[48:51], v[32:35]
    ds_read_b128 v[48:51], v24 offset:37888
    s_waitcnt lgkmcnt(11)
    v_mfma_f32_16x16x32_bf16 v[36:39], v[148:151], v[52:55], v[36:39]
    ds_read_b128 v[52:55], v25 offset:37888
    buffer_load_dwordx4 v[132:135], v11, s[60:63], s13 offen
    s_add_u32 s13, s13, 7168
    s_waitcnt vmcnt(17) lgkmcnt(11)
    v_mfma_f32_16x16x32_bf16 v[32:35], v[152:155], v[56:59], v[32:35]
    ds_read_b128 v[56:59], v24 offset:38912
    s_waitcnt lgkmcnt(11)
    v_mfma_f32_16x16x32_bf16 v[36:39], v[152:155], v[60:63], v[36:39]
    ds_read_b128 v[60:63], v25 offset:38912
    buffer_load_dwordx4 v[136:139], v11, s[60:63], s13 offen
    s_add_u32 s13, s13, 7168
    s_waitcnt vmcnt(17) lgkmcnt(11)
    v_mfma_f32_16x16x32_bf16 v[32:35], v[156:159], v[64:67], v[32:35]
    ds_read_b128 v[64:67], v24 offset:39936
    s_waitcnt lgkmcnt(11)
    v_mfma_f32_16x16x32_bf16 v[36:39], v[156:159], v[68:71], v[36:39]
    ds_read_b128 v[68:71], v25 offset:39936
    buffer_load_dwordx4 v[140:143], v11, s[60:63], s13 offen
    s_add_u32 s13, s13, 7168
    s_waitcnt vmcnt(16) lgkmcnt(11)
    v_mfma_f32_16x16x32_bf16 v[32:35], v[160:163], v[72:75], v[32:35]
    s_waitcnt vmcnt(21)
    s_barrier
    ds_read_b128 v[72:75], v24 offset:40960
    s_waitcnt lgkmcnt(11)
    v_mfma_f32_16x16x32_bf16 v[36:39], v[160:163], v[76:79], v[36:39]
    ds_read_b128 v[76:79], v25 offset:40960
    buffer_load_dwordx4 v[144:147], v11, s[60:63], s13 offen
    s_add_u32 s13, s13, 7168
    s_waitcnt vmcnt(16) lgkmcnt(11)
    v_mfma_f32_16x16x32_bf16 v[32:35], v[164:167], v[80:83], v[32:35]
    ds_read_b128 v[80:83], v24 offset:41984
    s_waitcnt lgkmcnt(11)
    v_mfma_f32_16x16x32_bf16 v[36:39], v[164:167], v[84:87], v[36:39]
    ds_read_b128 v[84:87], v25 offset:41984
    buffer_load_dwordx4 v[148:151], v11, s[60:63], s13 offen
    s_add_u32 s13, s13, 7168
    s_waitcnt vmcnt(16) lgkmcnt(11)
    v_mfma_f32_16x16x32_bf16 v[32:35], v[168:171], v[40:43], v[32:35]
    ds_read_b128 v[40:43], v24 offset:43008
    s_waitcnt lgkmcnt(11)
    v_mfma_f32_16x16x32_bf16 v[36:39], v[168:171], v[44:47], v[36:39]
    ds_read_b128 v[44:47], v25 offset:43008
    buffer_load_dwordx4 v[152:155], v11, s[60:63], s13 offen
    s_add_u32 s13, s13, 7168
    s_waitcnt vmcnt(15) lgkmcnt(11)
    v_mfma_f32_16x16x32_bf16 v[32:35], v[172:175], v[48:51], v[32:35]
    ds_read_b128 v[48:51], v24 offset:44032
    s_waitcnt lgkmcnt(11)
    v_mfma_f32_16x16x32_bf16 v[36:39], v[172:175], v[52:55], v[36:39]
    ds_read_b128 v[52:55], v25 offset:44032
    buffer_load_dwordx4 v[156:159], v11, s[60:63], s13 offen
    s_add_u32 s13, s13, 7168
    s_waitcnt vmcnt(15) lgkmcnt(11)
    v_mfma_f32_16x16x32_bf16 v[32:35], v[176:179], v[56:59], v[32:35]
    ds_read_b128 v[56:59], v24 offset:45056
    s_waitcnt lgkmcnt(11)
    v_mfma_f32_16x16x32_bf16 v[36:39], v[176:179], v[60:63], v[36:39]
    ds_read_b128 v[60:63], v25 offset:45056
    buffer_load_dwordx4 v[160:163], v11, s[60:63], s13 offen
    s_add_u32 s13, s13, 7168
    s_waitcnt vmcnt(15) lgkmcnt(11)
    v_mfma_f32_16x16x32_bf16 v[32:35], v[180:183], v[64:67], v[32:35]
    ds_read_b128 v[64:67], v24 offset:46080
    s_waitcnt lgkmcnt(11)
    v_mfma_f32_16x16x32_bf16 v[36:39], v[180:183], v[68:71], v[36:39]
    ds_read_b128 v[68:71], v25 offset:46080
    buffer_load_dwordx4 v[164:167], v11, s[60:63], s13 offen
    s_add_u32 s13, s13, 7168
    s_waitcnt vmcnt(15) lgkmcnt(11)
    v_mfma_f32_16x16x32_bf16 v[32:35], v[104:107], v[72:75], v[32:35]
    ds_read_b128 v[72:75], v24 offset:47104
    s_waitcnt lgkmcnt(11)
    v_mfma_f32_16x16x32_bf16 v[36:39], v[104:107], v[76:79], v[36:39]
    ds_read_b128 v[76:79], v25 offset:47104
    buffer_load_dwordx2 v[16:17], v14, s[64:67], s77 offen sc1
    buffer_load_dwordx2 v[20:21], v15, s[68:71], s9 offen sc1
    buffer_load_dwordx2 v[18:19], v14, s[64:67], s78 offen sc1
    buffer_load_dwordx2 v[22:23], v15, s[68:71], s10 offen sc1
    buffer_load_dwordx4 v[4:7], v7, s[72:75], s12 offen
    s_waitcnt vmcnt(19) lgkmcnt(11)
    v_mfma_f32_16x16x32_bf16 v[32:35], v[108:111], v[80:83], v[32:35]
    ds_read_b128 v[80:83], v24 offset:48128
    s_waitcnt lgkmcnt(11)
    v_mfma_f32_16x16x32_bf16 v[36:39], v[108:111], v[84:87], v[36:39]
    ds_read_b128 v[84:87], v25 offset:48128
    s_waitcnt vmcnt(18) lgkmcnt(11)
    v_mfma_f32_16x16x32_bf16 v[32:35], v[112:115], v[40:43], v[32:35]
    s_waitcnt vmcnt(24)
    s_barrier
    ds_read_b128 v[40:43], v24 offset:49152
    s_waitcnt lgkmcnt(11)
    v_mfma_f32_16x16x32_bf16 v[36:39], v[112:115], v[44:47], v[36:39]
    ds_read_b128 v[44:47], v25 offset:49152
    s_waitcnt vmcnt(17) lgkmcnt(11)
    v_mfma_f32_16x16x32_bf16 v[32:35], v[116:119], v[48:51], v[32:35]
    ds_read_b128 v[48:51], v24 offset:50176
    s_waitcnt lgkmcnt(11)
    v_mfma_f32_16x16x32_bf16 v[36:39], v[116:119], v[52:55], v[36:39]
    ds_read_b128 v[52:55], v25 offset:50176
    s_waitcnt vmcnt(16) lgkmcnt(11)
    v_mfma_f32_16x16x32_bf16 v[32:35], v[120:123], v[56:59], v[32:35]
    ds_read_b128 v[56:59], v24 offset:51200
    s_waitcnt lgkmcnt(11)
    v_mfma_f32_16x16x32_bf16 v[36:39], v[120:123], v[60:63], v[36:39]
    ds_read_b128 v[60:63], v25 offset:51200
    s_waitcnt vmcnt(15) lgkmcnt(11)
    v_mfma_f32_16x16x32_bf16 v[32:35], v[124:127], v[64:67], v[32:35]
    ds_read_b128 v[64:67], v24 offset:52224
    s_waitcnt lgkmcnt(11)
    v_mfma_f32_16x16x32_bf16 v[36:39], v[124:127], v[68:71], v[36:39]
    ds_read_b128 v[68:71], v25 offset:52224
    s_waitcnt vmcnt(14) lgkmcnt(11)
    v_mfma_f32_16x16x32_bf16 v[32:35], v[128:131], v[72:75], v[32:35]
    ds_read_b128 v[72:75], v24 offset:53248
    s_waitcnt lgkmcnt(11)
    v_mfma_f32_16x16x32_bf16 v[36:39], v[128:131], v[76:79], v[36:39]
    ds_read_b128 v[76:79], v25 offset:53248
    s_waitcnt vmcnt(13) lgkmcnt(11)
    v_mfma_f32_16x16x32_bf16 v[32:35], v[132:135], v[80:83], v[32:35]
    ds_read_b128 v[80:83], v24 offset:54272
    s_waitcnt lgkmcnt(11)
    v_mfma_f32_16x16x32_bf16 v[36:39], v[132:135], v[84:87], v[36:39]
    ds_read_b128 v[84:87], v25 offset:54272
    s_waitcnt vmcnt(12) lgkmcnt(11)
    v_mfma_f32_16x16x32_bf16 v[32:35], v[136:139], v[40:43], v[32:35]
    ds_read_b128 v[40:43], v24 offset:55296
    s_waitcnt lgkmcnt(11)
    v_mfma_f32_16x16x32_bf16 v[36:39], v[136:139], v[44:47], v[36:39]
    ds_read_b128 v[44:47], v25 offset:55296
    s_waitcnt vmcnt(11) lgkmcnt(11)
    v_mfma_f32_16x16x32_bf16 v[32:35], v[140:143], v[48:51], v[32:35]
    ds_read_b128 v[48:51], v24 offset:56320
    s_waitcnt lgkmcnt(11)
    v_mfma_f32_16x16x32_bf16 v[36:39], v[140:143], v[52:55], v[36:39]
    ds_read_b128 v[52:55], v25 offset:56320
    s_waitcnt vmcnt(10) lgkmcnt(11)
    v_mfma_f32_16x16x32_bf16 v[32:35], v[144:147], v[56:59], v[32:35]
    s_waitcnt lgkmcnt(10)
    v_mfma_f32_16x16x32_bf16 v[36:39], v[144:147], v[60:63], v[36:39]
    s_waitcnt vmcnt(9) lgkmcnt(9)
    v_mfma_f32_16x16x32_bf16 v[32:35], v[148:151], v[64:67], v[32:35]
    s_waitcnt lgkmcnt(8)
    v_mfma_f32_16x16x32_bf16 v[36:39], v[148:151], v[68:71], v[36:39]
    s_waitcnt vmcnt(8) lgkmcnt(7)
    v_mfma_f32_16x16x32_bf16 v[32:35], v[152:155], v[72:75], v[32:35]
    s_waitcnt lgkmcnt(6)
    v_mfma_f32_16x16x32_bf16 v[36:39], v[152:155], v[76:79], v[36:39]
    s_waitcnt vmcnt(7) lgkmcnt(5)
    v_mfma_f32_16x16x32_bf16 v[32:35], v[156:159], v[80:83], v[32:35]
    s_waitcnt lgkmcnt(4)
    v_mfma_f32_16x16x32_bf16 v[36:39], v[156:159], v[84:87], v[36:39]
    s_waitcnt vmcnt(6) lgkmcnt(3)
    v_mfma_f32_16x16x32_bf16 v[32:35], v[160:163], v[40:43], v[32:35]
    s_waitcnt lgkmcnt(2)
    v_mfma_f32_16x16x32_bf16 v[36:39], v[160:163], v[44:47], v[36:39]
    s_waitcnt vmcnt(5) lgkmcnt(1)
    v_mfma_f32_16x16x32_bf16 v[32:35], v[164:167], v[48:51], v[32:35]
    s_waitcnt lgkmcnt(0)
    v_mfma_f32_16x16x32_bf16 v[36:39], v[164:167], v[52:55], v[36:39]
    s_waitcnt vmcnt(0)
    s_nop 4
    v_cvt_pk_bf16_f32 v32, 0, v32
    v_cvt_pk_bf16_f32 v33, 0, v33
    v_cvt_pk_bf16_f32 v34, 0, v34
    v_cvt_pk_bf16_f32 v35, 0, v35
    v_lshlrev_b32 v66, 16, v16
    v_and_b32 v67, 0xffff0000, v16
    v_lshlrev_b32 v68, 16, v17
    v_and_b32 v69, 0xffff0000, v17
    v_add_f32 v32, v32, v66
    v_add_f32 v33, v33, v67
    v_add_f32 v34, v34, v68
    v_add_f32 v35, v35, v69
    v_cvt_pk_bf16_f32 v32, 0, v32
    v_cvt_pk_bf16_f32 v33, 0, v33
    v_cvt_pk_bf16_f32 v34, 0, v34
    v_cvt_pk_bf16_f32 v35, 0, v35
    v_mul_f32 v32, v32, v4
    v_mul_f32 v33, v33, v5
    v_mul_f32 v34, v34, v6
    v_mul_f32 v35, v35, v7
    v_cvt_pk_bf16_f32 v32, 0, v32
    v_cvt_pk_bf16_f32 v33, 0, v33
    v_cvt_pk_bf16_f32 v34, 0, v34
    v_cvt_pk_bf16_f32 v35, 0, v35
    v_lshlrev_b32 v66, 16, v20
    v_and_b32 v67, 0xffff0000, v20
    v_lshlrev_b32 v68, 16, v21
    v_and_b32 v69, 0xffff0000, v21
    v_add_f32 v32, v32, v66
    v_add_f32 v33, v33, v67
    v_add_f32 v34, v34, v68
    v_add_f32 v35, v35, v69
    v_cvt_pk_bf16_f32 v70, v32, v33
    v_cvt_pk_bf16_f32 v71, v34, v35
    buffer_store_dwordx2 v[70:71], v15, s[84:87], s9 offen
    v_cvt_pk_bf16_f32 v36, 0, v36
    v_cvt_pk_bf16_f32 v37, 0, v37
    v_cvt_pk_bf16_f32 v38, 0, v38
    v_cvt_pk_bf16_f32 v39, 0, v39
    v_lshlrev_b32 v66, 16, v18
    v_and_b32 v67, 0xffff0000, v18
    v_lshlrev_b32 v68, 16, v19
    v_and_b32 v69, 0xffff0000, v19
    v_add_f32 v36, v36, v66
    v_add_f32 v37, v37, v67
    v_add_f32 v38, v38, v68
    v_add_f32 v39, v39, v69
    v_cvt_pk_bf16_f32 v36, 0, v36
    v_cvt_pk_bf16_f32 v37, 0, v37
    v_cvt_pk_bf16_f32 v38, 0, v38
    v_cvt_pk_bf16_f32 v39, 0, v39
    v_mul_f32 v36, v36, v4
    v_mul_f32 v37, v37, v5
    v_mul_f32 v38, v38, v6
    v_mul_f32 v39, v39, v7
    v_cvt_pk_bf16_f32 v36, 0, v36
    v_cvt_pk_bf16_f32 v37, 0, v37
    v_cvt_pk_bf16_f32 v38, 0, v38
    v_cvt_pk_bf16_f32 v39, 0, v39
    v_lshlrev_b32 v66, 16, v22
    v_and_b32 v67, 0xffff0000, v22
    v_lshlrev_b32 v68, 16, v23
    v_and_b32 v69, 0xffff0000, v23
    v_add_f32 v36, v36, v66
    v_add_f32 v37, v37, v67
    v_add_f32 v38, v38, v68
    v_add_f32 v39, v39, v69
    v_cvt_pk_bf16_f32 v72, v36, v37
    v_cvt_pk_bf16_f32 v73, v38, v39
    buffer_store_dwordx2 v[72:73], v15, s[84:87], s10 offen
    s_endpgm
kb_kernel_w727:
    s_add_u32 m0, s76, 0
    s_add_u32 s15, s20, 0
    buffer_load_dwordx4 v10, s[56:59], s15 offen sc1 lds
    s_add_u32 m0, s76, 4096
    s_add_u32 s15, s20, 4096
    buffer_load_dwordx4 v10, s[56:59], s15 offen sc1 lds
    s_add_u32 m0, s76, 8192
    s_add_u32 s15, s20, 8192
    buffer_load_dwordx4 v10, s[56:59], s15 offen sc1 lds
    s_add_u32 m0, s76, 12288
    s_add_u32 s15, s20, 12288
    buffer_load_dwordx4 v10, s[56:59], s15 offen sc1 lds
    s_add_u32 m0, s76, 16384
    s_add_u32 s15, s20, 16384
    buffer_load_dwordx4 v10, s[56:59], s15 offen sc1 lds
    s_add_u32 m0, s76, 20480
    s_add_u32 s15, s20, 20480
    buffer_load_dwordx4 v10, s[56:59], s15 offen sc1 lds
    s_add_u32 m0, s76, 24576
    s_add_u32 s15, s20, 24576
    buffer_load_dwordx4 v10, s[56:59], s15 offen sc1 lds
    s_add_u32 m0, s76, 28672
    s_add_u32 s15, s20, 28672
    buffer_load_dwordx4 v10, s[56:59], s15 offen sc1 lds
    s_add_u32 m0, s76, 32768
    s_add_u32 s15, s20, 32768
    buffer_load_dwordx4 v10, s[56:59], s15 offen sc1 lds
    s_add_u32 m0, s76, 36864
    s_add_u32 s15, s20, 36864
    buffer_load_dwordx4 v10, s[56:59], s15 offen sc1 lds
    s_add_u32 m0, s76, 40960
    s_add_u32 s15, s20, 40960
    buffer_load_dwordx4 v10, s[56:59], s15 offen sc1 lds
    s_add_u32 m0, s76, 45056
    s_add_u32 s15, s20, 45056
    buffer_load_dwordx4 v10, s[56:59], s15 offen sc1 lds
    s_add_u32 m0, s76, 49152
    s_add_u32 s15, s20, 49152
    buffer_load_dwordx4 v10, s[56:59], s15 offen sc1 lds
    s_add_u32 m0, s76, 53248
    s_add_u32 s15, s20, 53248
    buffer_load_dwordx4 v10, s[56:59], s15 offen sc1 lds
    s_waitcnt vmcnt(13)
    s_barrier
    s_waitcnt vmcnt(12)
    s_barrier
    s_waitcnt vmcnt(10)
    s_barrier
    s_waitcnt vmcnt(8)
    s_barrier
    s_waitcnt vmcnt(6)
    s_barrier
    s_waitcnt vmcnt(4)
    s_barrier
    s_waitcnt vmcnt(2)
    s_barrier
    s_waitcnt vmcnt(0)
    s_barrier
kb_end:
    s_endpgm

.section .rodata,"a"
.p2align 6
.amdhsa_kernel ka_kernel
  .amdhsa_next_free_vgpr 162
  .amdhsa_next_free_sgpr 72
  .amdhsa_accum_offset 164
  .amdhsa_group_segment_fixed_size 0
  .amdhsa_kernarg_size 152
  .amdhsa_user_sgpr_count 2
  .amdhsa_user_sgpr_kernarg_segment_ptr 1
  .amdhsa_system_sgpr_workgroup_id_x 1
.end_amdhsa_kernel

.p2align 6
.amdhsa_kernel kb_kernel
  .amdhsa_next_free_vgpr 252
  .amdhsa_next_free_sgpr 100
  .amdhsa_accum_offset 252
  .amdhsa_group_segment_fixed_size 0
  .amdhsa_kernarg_size 152
  .amdhsa_user_sgpr_count 2
  .amdhsa_user_sgpr_kernarg_segment_ptr 1
  .amdhsa_system_sgpr_workgroup_id_x 1
.end_amdhsa_kernel
```
